```python
import torch

def _softmax(x, axis=-1):
    return torch.softmax(x, dim=axis)
def _gelu(x):
    return torch.nn.functional.gelu(x, approximate="tanh")
def _silu(x):
    return torch.nn.functional.silu(x)
def _sigmoid(x):
    return torch.sigmoid(x)
def _layernorm(x, axis=-1, eps=1e-5):
    m = x.mean(dim=axis, keepdim=True)
    v = x.var(dim=axis, keepdim=True, unbiased=False)
    return (x - m) / torch.sqrt(v + eps)
def _scatter_add(tgt, idx, src, axis=0):
    return tgt.clone().index_add_(axis, idx, src)
def _segment_sum(src, seg, n):
    out = torch.zeros((n,) + src.shape[1:], dtype=src.dtype)
    return out.index_add_(0, seg, src)
def _pad(x, pw):
    flat = tuple(v for pair in reversed(pw) for v in pair)
    return torch.nn.functional.pad(x, flat)

kernel_name = 'standalone__convnext_block__vision'

def setup_inputs():

    _w = (lambda a: (lambda t: t.to(torch.bfloat16) if t.is_floating_point() else t)(torch.as_tensor(a)))
    H = W = 512
    C = 96
    return {
        "x": _w((lambda *s: torch.randn(*s, dtype=torch.bfloat16) * 0.05)(1, H, W, C)),
        "dw": _w((lambda *s: torch.randn(*s, dtype=torch.bfloat16) * 0.05)(7, 7, C)),
        "w1": _w((lambda *s: torch.randn(*s, dtype=torch.bfloat16) * 0.05)(C, 4 * C)),
        "w2": _w((lambda *s: torch.randn(*s, dtype=torch.bfloat16) * 0.05)(4 * C, C)),
    }

def reference(x, dw, w1, w2):
    B, H, W, C = x.shape
    pad = 3
    xp = _pad(x, ((0,0),(pad,pad),(pad,pad),(0,0)))
    out = torch.zeros_like(x)
    for i in range(7):
        for j in range(7):
            out = out + xp[:, i:i+H, j:j+W, :] * dw[i, j][None, None, None, :]
    h = _layernorm(out, axis=-1)
    return x + _gelu(h @ w1) @ w2
```

```asm
; @launch grid=(256,1,1) block=(256,1,1) lds=163312
.amdgcn_target "amdgcn-amd-amdhsa--gfx950"
.text
.globl standalone__convnext_block__vision_kernel
.p2align 8
.type standalone__convnext_block__vision_kernel,@function
standalone__convnext_block__vision_kernel:
    s_cmp_ge_u32 s2, 0x100
    s_cbranch_scc1 L_end
    s_load_dwordx8 s[4:11], s[0:1], 0
    s_load_dwordx2 s[12:13], s[0:1], 32
    s_getpc_b64 s[16:17]
L_pc:
    v_lshlrev_b32 v222, 7, v0
    v_min_u32 v222, L_end-L_pc, v222
    v_mov_b32 v223, s17
    v_add_co_u32 v222, vcc, s16, v222
    s_nop 1
    v_addc_co_u32 v223, vcc, 0, v223, vcc
    global_load_dword v199, v[222:223], off
    v_and_b32 v176, 63, v0
    v_lshrrev_b32 v177, 6, v0
    v_and_b32 v200, 15, v176
    v_readfirstlane_b32 s40, v177
    v_lshrrev_b32 v201, 4, v176
    v_lshlrev_b32 v1, 4, v176
    s_and_b32 s56, s2, 1
    s_lshl_b32 s56, s56, 8
    s_and_b32 s53, s2, 0x78
    s_lshl_b32 s53, s53, 1
    s_add_u32 s53, s53, s56
    s_mul_i32 s69, s53, 0xc0
    s_lshr_b32 s54, s2, 7
    s_and_b32 s66, s2, 6
    s_lshl_b32 s66, s66, 6
    s_add_u32 s66, s66, 64
    s_cmp_eq_u32 s54, 0
    s_cselect_b32 s3, 0, -1
    s_cselect_b32 s67, -3, 2
    s_cselect_b32 s61, 1, -1
    s_cselect_b32 s62, 0, 6
    s_cselect_b32 s56, 0x1c0, 64
    s_cmp_eq_u32 s66, s56
    s_cselect_b32 s44, 3, 6
    s_add_u32 s68, s44, 63
    s_add_u32 s44, s44, 64
    s_mul_i32 s77, s61, 0x18000
    s_mul_i32 s55, s61, 0xc0000
    s_add_u32 s51, s66, s67
    s_mov_b32 s52, s66
    v_and_b32 v204, 1, v201
    v_xor_b32 v204, s54, v204
    v_mul_u32_u24 v204, 0x18000, v204
    v_mul_u32_u24 v205, 0xc0, v200
    v_add_u32 v204, v204, v205
    v_and_b32 v205, 2, v201
    v_lshlrev_b32 v205, 3, v205
    v_add_u32 v8, v204, v205
    v_and_b32_e64 v9, 16, v8
    v_mad_u32_u24 v9, v9, 7, v8
    s_mov_b32 s58, 0xaaab
    s_mov_b32 s59, 0x80000000
    s_movk_i32 s63, 0x3e1
    s_movk_i32 s64, 0xc0
    s_mul_i32 s60, s40, 48
    s_mul_i32 s65, s40, 0x4800
    v_lshrrev_b32 v178, 3, v176
    v_and_b32 v179, 7, v176
    v_max_u32 v180, v178, v179
    v_mul_i32_i24 v178, s61, v178
    v_add_u32 v178, s62, v178
    v_mad_i32_i24 v178, v178, 7, v179
    v_mul_u32_u24 v178, s64, v178
    v_add_u32 v180, 1, v180
    v_lshlrev_b32 v180, 28, v180
    v_and_b32 v180, s59, v180
    v_or_b32 v124, v178, v180
    v_add_u32 v178, 0, v176
    v_mul_u32_u24 v179, s58, v178
    v_lshrrev_b32 v179, 21, v179
    v_lshlrev_b32 v179, 2, v179
    v_xor_b32 v178, v176, v179
    v_lshlrev_b32 v120, 4, v178
    v_add_u32 v178, 64, v176
    v_mul_u32_u24 v179, s58, v178
    v_lshrrev_b32 v179, 21, v179
    v_lshlrev_b32 v179, 2, v179
    v_xor_b32 v178, v176, v179
    v_lshlrev_b32 v121, 4, v178
    v_add_u32 v178, 0x80, v176
    v_mul_u32_u24 v179, s58, v178
    v_lshrrev_b32 v179, 21, v179
    v_lshlrev_b32 v179, 2, v179
    v_xor_b32 v178, v176, v179
    v_lshlrev_b32 v122, 4, v178
    s_sub_u32 s57, s53, 3
    v_add_u32 v178, 0, v176
    v_mul_u32_u24 v179, s63, v178
    v_lshrrev_b32 v179, 16, v179
    v_mad_i32_i24 v180, v179, -2, v178
    v_lshlrev_b32 v184, 6, v179
    v_sub_u32 v180, v180, v184
    v_mul_u32_u24 v181, s58, v180
    v_lshrrev_b32 v181, 18, v181
    v_add_u32 v182, 28, v180
    v_lshrrev_b32 v182, 6, v182
    v_mul_u32_u24 v182, 22, v182
    v_and_b32 v183, 1, v179
    v_lshl_add_u32 v183, v181, 2, v183
    v_sub_u32 v183, v183, v182
    v_add_u32 v183, s57, v183
    v_lshrrev_b32 v182, 9, v183
    v_mad_i32_i24 v180, v181, -6, v180
    v_lshrrev_b32 v179, 1, v179
    v_mad_u32_u24 v180, v179, 6, v180
    v_mul_u32_u24 v184, s64, v183
    v_lshl_add_u32 v184, v180, 4, v184
    v_add_u32 v184, 0xc80, v184
    v_min_u32 v182, 1, v182
    v_lshlrev_b32 v182, 31, v182
    v_or_b32 v112, v184, v182
    v_add_u32 v178, 64, v176
    v_mul_u32_u24 v179, s63, v178
    v_lshrrev_b32 v179, 16, v179
    v_mad_i32_i24 v180, v179, -2, v178
    v_lshlrev_b32 v184, 6, v179
    v_sub_u32 v180, v180, v184
    v_mul_u32_u24 v181, s58, v180
    v_lshrrev_b32 v181, 18, v181
    v_add_u32 v182, 28, v180
    v_lshrrev_b32 v182, 6, v182
    v_mul_u32_u24 v182, 22, v182
    v_and_b32 v183, 1, v179
    v_lshl_add_u32 v183, v181, 2, v183
    v_sub_u32 v183, v183, v182
    v_add_u32 v183, s57, v183
    v_lshrrev_b32 v182, 9, v183
    v_mad_i32_i24 v180, v181, -6, v180
    v_lshrrev_b32 v179, 1, v179
    v_mad_u32_u24 v180, v179, 6, v180
    v_mul_u32_u24 v184, s64, v183
    v_lshl_add_u32 v184, v180, 4, v184
    v_add_u32 v184, 0x880, v184
    v_min_u32 v182, 1, v182
    v_lshlrev_b32 v182, 31, v182
    v_or_b32 v113, v184, v182
    v_add_u32 v178, 0x80, v176
    v_mul_u32_u24 v179, s63, v178
    v_lshrrev_b32 v179, 16, v179
    v_mad_i32_i24 v180, v179, -2, v178
    v_lshlrev_b32 v184, 6, v179
    v_sub_u32 v180, v180, v184
    v_mul_u32_u24 v181, s58, v180
    v_lshrrev_b32 v181, 18, v181
    v_add_u32 v182, 28, v180
    v_lshrrev_b32 v182, 6, v182
    v_mul_u32_u24 v182, 22, v182
    v_and_b32 v183, 1, v179
    v_lshl_add_u32 v183, v181, 2, v183
    v_sub_u32 v183, v183, v182
    v_add_u32 v183, s57, v183
    v_lshrrev_b32 v182, 9, v183
    v_mad_i32_i24 v180, v181, -6, v180
    v_lshrrev_b32 v179, 1, v179
    v_mad_u32_u24 v180, v179, 6, v180
    v_mul_u32_u24 v184, s64, v183
    v_lshl_add_u32 v184, v180, 4, v184
    v_add_u32 v184, 0x480, v184
    v_min_u32 v182, 1, v182
    v_lshlrev_b32 v182, 31, v182
    v_or_b32 v114, v184, v182
    v_add_u32 v178, 0xc0, v176
    v_mul_u32_u24 v179, s63, v178
    v_lshrrev_b32 v179, 16, v179
    v_mad_i32_i24 v180, v179, -2, v178
    v_lshlrev_b32 v184, 6, v179
    v_sub_u32 v180, v180, v184
    v_mul_u32_u24 v181, s58, v180
    v_lshrrev_b32 v181, 18, v181
    v_add_u32 v182, 28, v180
    v_lshrrev_b32 v182, 6, v182
    v_mul_u32_u24 v182, 22, v182
    v_and_b32 v183, 1, v179
    v_lshl_add_u32 v183, v181, 2, v183
    v_sub_u32 v183, v183, v182
    v_add_u32 v183, s57, v183
    v_lshrrev_b32 v182, 9, v183
    v_mad_i32_i24 v180, v181, -6, v180
    v_lshrrev_b32 v179, 1, v179
    v_mad_u32_u24 v180, v179, 6, v180
    v_mul_u32_u24 v184, s64, v183
    v_lshl_add_u32 v184, v180, 4, v184
    v_add_u32 v184, 0x80, v184
    v_min_u32 v182, 1, v182
    v_lshlrev_b32 v182, 31, v182
    v_or_b32 v115, v184, v182
    v_add_u32 v178, 0xc8, v176
    v_mul_u32_u24 v179, s63, v178
    v_lshrrev_b32 v179, 16, v179
    v_mad_i32_i24 v180, v179, -2, v178
    v_lshlrev_b32 v184, 6, v179
    v_sub_u32 v180, v180, v184
    v_mul_u32_u24 v181, s58, v180
    v_lshrrev_b32 v181, 18, v181
    v_add_u32 v182, 28, v180
    v_lshrrev_b32 v182, 6, v182
    v_mul_u32_u24 v182, 22, v182
    v_and_b32 v183, 1, v179
    v_lshl_add_u32 v183, v181, 2, v183
    v_sub_u32 v183, v183, v182
    v_add_u32 v183, s57, v183
    v_lshrrev_b32 v182, 9, v183
    v_mad_i32_i24 v180, v181, -6, v180
    v_lshrrev_b32 v179, 1, v179
    v_mad_u32_u24 v180, v179, 6, v180
    v_mul_u32_u24 v184, s64, v183
    v_lshl_add_u32 v184, v180, 4, v184
    v_add_u32 v184, 0, v184
    v_min_u32 v182, 1, v182
    v_lshlrev_b32 v182, 31, v182
    v_or_b32 v116, v184, v182
    s_lshr_b32 s66, s2, 3
    s_lshl_b32 s66, s66, 1
    s_and_b32 s67, s40, 1
    s_add_u32 s66, s66, s67
    s_mul_i32 s66, s66, 0x480
    v_add_u32 v220, 55, v176
    v_lshrrev_b32 v220, 6, v220
    v_lshlrev_b32 v220, 20, v220
    v_lshl_add_u32 v220, v176, 7, v220
    v_add_u32_e64 v220, s66, v220
    s_waitcnt lgkmcnt(0)
    s_mul_i32 s0, s51, 0x18000
    s_mov_b32 s1, s52
    s_mov_b32 s24, s6
    s_mov_b32 s25, s7
    s_mov_b32 s26, 0x24c0
    s_mov_b32 s27, 0x20000
    s_mov_b32 s6, 0x3000000
    s_mov_b32 s7, 0x20000
    s_cmp_lt_u32 s40, 2
    s_cselect_b32 s20, s8, s10
    s_cselect_b32 s21, s9, s11
    s_mov_b32 s22, 0x12000
    s_mov_b32 s23, 0x20000
    buffer_load_dword v219, v220, s[20:23], 0 offen
    buffer_load_dwordx4 v[128:131], v124, s[24:27], s60 offen
    buffer_load_dwordx4 v[132:135], v124, s[24:27], s60 offen offset:16
    buffer_load_dwordx4 v[136:139], v124, s[24:27], s60 offen offset:32
    s_mov_b32 s20, s8
    s_mov_b32 s21, s9
    s_mov_b32 s22, 0x12000
    s_mov_b32 s23, 0x20000
    s_mov_b32 s19, 0x20000
    s_mov_b32 s18, 0x18c80
    s_sub_u32 s56, s0, 0xc80
    s_mov_b32 s66, s40
    s_mul_i32 s67, s66, s77
    s_add_u32 s67, s67, s56
    s_add_u32 s16, s4, s67
    s_addc_u32 s17, s5, 0
    s_lshr_b32 s67, s66, 1
    s_mul_i32 s62, s67, 0x2120
    s_and_b32 s67, s67, 3
    s_lshl_b32 s67, s67, 3
    s_add_u32 s62, s62, s67
    s_and_b32 s67, s66, 1
    s_mul_i32 s67, s67, 0x1080
    s_add_u32 m0, s62, s67
    s_nop 0
    buffer_load_dwordx4 v112, s[16:19], 0 offen lds
    s_mov_b32 s32, 0x409d30fc
    s_mov_b32 s33, 0x409d30fc
    s_mov_b32 s34, 0x3eeff558
    s_mov_b32 s35, 0x3eeff558
    s_mov_b32 s36, 0x3c2aaaab
    s_mov_b32 s37, 0x3c2aaaab
    s_mov_b32 s38, 0x3727c5ac
    s_mov_b32 s39, 0x3727c5ac
    s_mov_b32 s51, 0x3f80
    s_mov_b32 s52, 0x3f800000
    s_xor_b32 s14, s40, 1
    s_mul_i32 s46, s40, 0x1810
    buffer_load_dwordx4 v113, s[16:19], 0 offen offset:1024 lds
    s_add_u32 s46, s46, 0x21db0
    s_mul_i32 s47, s14, 0x1810
    s_add_u32 s47, s47, 0x21db0
    s_mul_i32 s48, s40, 0x3000
    s_add_u32 s48, s48, 0x15db0
    s_mul_i32 s49, s14, 0x3000
    s_add_u32 s49, s49, 0x15db0
    s_lshl_b32 s50, s40, 10
    s_add_u32 s50, s50, 0x14830
    s_add_u32 s14, s14, s54
    s_lshl_b32 s14, s14, 1
    s_mul_i32 s14, s14, s77
    s_mul_i32 s1, s1, 0x18000
    s_add_u32 s1, s1, s14
    s_add_u32 s1, s1, s69
    s_mov_b32 s41, 6
    buffer_load_dwordx4 v114, s[16:19], 0 offen offset:2048 lds
    v_and_b32 v202, 3, v176
    v_lshrrev_b32 v203, 2, v200
    s_lshr_b32 s14, s40, 1
    s_mul_i32 s14, s14, 0x840
    s_and_b32 s15, s40, 1
    s_mul_i32 s15, s15, 48
    s_add_u32 s14, s14, s15
    v_and_b32 v207, 1, v201
    v_mul_u32_u24 v207, 0x1080, v207
    v_mul_u32_u24 v208, 0x60, v203
    v_add_u32 v207, v207, v208
    v_add_u32 v207, s14, v207
    v_lshrrev_b32 v208, 1, v201
    v_add_u32 v208, v208, v202
    v_mul_u32_u24 v2, 0x2120, v208
    buffer_load_dwordx4 v115, s[16:19], 0 offen offset:3072 lds
    v_and_b32 v206, 3, v208
    v_lshlrev_b32 v206, 3, v206
    v_add_u32 v2, v2, v206
    v_add_u32 v2, v2, v207
    v_add_u32 v208, 2, v208
    v_mul_u32_u24 v3, 0x2120, v208
    v_and_b32 v206, 3, v208
    v_lshlrev_b32 v206, 3, v206
    v_add_u32 v3, v3, v206
    v_add_u32 v3, v3, v207
    v_mul_u32_u24 v207, 0x602, v202
    v_and_b32 v208, 1, v201
    v_lshlrev_b32 v208, 4, v208
    v_add_u32 v207, v207, v208
    buffer_load_dwordx4 v116, s[16:19], 0 offen offset:3200 lds
    v_and_b32 v208, 2, v201
    v_add_u32 v207, v207, v208
    v_and_b32 v208, 8, v176
    v_sub_u32 v207, v207, v208
    v_and_b32 v208, 1, v203
    v_sub_u32 v207, v207, v208
    v_lshlrev_b32 v207, 2, v207
    s_mul_i32 s2, s40, 0x600
    s_add_u32 s14, s2, 0xe808
    v_add_u32 v4, s14, v207
    v_add_u32 v5, 0x300, v4
    v_mul_u32_u24 v6, 0x5555, v202
    v_and_b32 v207, 28, v176
    v_bcnt_u32_b32 v207, v207, 0
    s_add_u32 s66, s40, 4
    s_mul_i32 s67, s66, s77
    s_add_u32 s67, s67, s56
    s_add_u32 s16, s4, s67
    s_addc_u32 s17, s5, 0
    s_lshr_b32 s67, s66, 1
    s_mul_i32 s62, s67, 0x2120
    s_and_b32 s67, s67, 3
    s_lshl_b32 s67, s67, 3
    s_add_u32 s62, s62, s67
    s_and_b32 s67, s66, 1
    s_mul_i32 s67, s67, 0x1080
    s_add_u32 m0, s62, s67
    s_nop 0
    buffer_load_dwordx4 v112, s[16:19], 0 offen lds
    v_and_b32 v207, 1, v207
    v_and_b32 v208, 2, v201
    v_add_u32 v207, v207, v208
    v_lshl_add_u32 v207, v203, 2, v207
    v_mul_u32_u24 v207, 0x10c0, v207
    v_lshl_add_u32 v207, v202, 4, v207
    v_lshl_add_u32 v6, v207, 16, v6
    v_lshlrev_b32 v206, 2, v176
    v_add_u32 v206, s14, v206
    s_mov_b32 s15, 0xffff
    v_add_u32 v220, 0x1808, v206
    buffer_load_dwordx4 v113, s[16:19], 0 offen offset:1024 lds
    v_add_u32 v221, 0x3010, v206
    v_add_u32 v209, 0x4818, v206
    s_waitcnt vmcnt(9)
    v_and_b32 v210, s15, v128
    v_lshrrev_b32 v211, 16, v128
    v_and_b32 v212, s15, v129
    v_lshrrev_b32 v213, 16, v129
    v_and_b32 v214, s15, v130
    v_lshrrev_b32 v215, 16, v130
    v_and_b32 v216, s15, v131
    v_lshrrev_b32_e64 v217, 16, v131
    ds_write2st64_b32 v206, v210, v214 offset0:0 offset1:1
    buffer_load_dwordx4 v114, s[16:19], 0 offen offset:2048 lds
    ds_write2st64_b32 v220, v211, v215 offset0:0 offset1:1
    ds_write2st64_b32 v221, v212, v216 offset0:0 offset1:1
    ds_write2st64_b32 v209, v213, v217 offset0:0 offset1:1
    s_waitcnt vmcnt(9)
    v_and_b32 v210, s15, v132
    v_lshrrev_b32 v211, 16, v132
    v_and_b32 v212, s15, v133
    v_lshrrev_b32 v213, 16, v133
    v_and_b32 v214, s15, v134
    buffer_load_dwordx4 v115, s[16:19], 0 offen offset:3072 lds
    v_lshrrev_b32 v215, 16, v134
    v_and_b32 v216, s15, v135
    v_lshrrev_b32_e64 v217, 16, v135
    ds_write2st64_b32 v206, v210, v214 offset0:2 offset1:3
    ds_write2st64_b32 v220, v211, v215 offset0:2 offset1:3
    ds_write2st64_b32 v221, v212, v216 offset0:2 offset1:3
    buffer_load_dwordx4 v116, s[16:19], 0 offen offset:3200 lds
    ds_write2st64_b32 v209, v213, v217 offset0:2 offset1:3
    s_waitcnt vmcnt(10)
    v_and_b32 v210, s15, v136
    v_lshrrev_b32 v211, 16, v136
    v_and_b32 v212, s15, v137
    v_lshrrev_b32 v213, 16, v137
    v_and_b32 v214, s15, v138
    v_lshrrev_b32 v215, 16, v138
    v_and_b32 v216, s15, v139
    v_lshrrev_b32 v217, 16, v139
    ds_write2st64_b32 v206, v210, v214 offset0:4 offset1:5
    s_and_b32 s66, s40, 1
    s_add_u32 s66, s66, 8
    s_mul_i32 s67, s66, s77
    s_add_u32 s67, s67, s56
    s_add_u32 s16, s4, s67
    s_addc_u32 s17, s5, 0
    s_lshr_b32 s67, s66, 1
    s_mul_i32 s62, s67, 0x2120
    s_and_b32 s67, s67, 3
    s_lshl_b32 s67, s67, 3
    s_add_u32 s62, s62, s67
    s_and_b32 s67, s66, 1
    s_mul_i32 s67, s67, 0x1080
    s_add_u32 m0, s62, s67
    s_nop 0
    buffer_load_dwordx4 v112, s[16:19], 0 offen lds
    ds_write2st64_b32 v220, v211, v215 offset0:4 offset1:5
    ds_write2st64_b32 v221, v212, v216 offset0:4 offset1:5
    ds_write2st64_b32 v209, v213, v217 offset0:4 offset1:5
    v_mov_b32 v218, 0
    v_mov_b32 v219, 0
    buffer_load_dwordx4 v113, s[16:19], 0 offen offset:1024 lds
    v_lshlrev_b32_e64 v207, 3, v176
    v_add_u32 v207, 0xe7e0, v207
    v_mul_u32_u24 v208, 0x1808, v176
    v_add_u32 v208, 0x10008, v208
    s_mov_b64 exec, 0x1f
    ds_write_b64 v207, v[218:219]
    s_mov_b64 exec, 0xf
    ds_write_b64 v208, v[218:219]
    s_mov_b64 exec, -1
    v_mul_u32_u24 v207, 0x1810, v202
    buffer_load_dwordx4 v114, s[16:19], 0 offen offset:2048 lds
    v_lshlrev_b32 v208, 6, v203
    v_add_u32 v207, v207, v208
    v_and_b32 v208, 2, v201
    v_lshlrev_b32 v208, 7, v208
    v_add_u32 v207, v207, v208
    v_and_b32 v208, 1, v201
    v_lshlrev_b32 v208, 4, v208
    v_add_u32 v207, v207, v208
    s_add_u32 s14, s2, 0x21db0
    v_add_u32 v7, s14, v207
    v_lshrrev_b32 v188, 2, v200
    v_and_b32 v189, 3, v176
    v_and_b32 v190, 1, v201
    v_lshrrev_b32 v191, 1, v201
    buffer_load_dwordx4 v115, s[16:19], 0 offen offset:3072 lds
    v_lshlrev_b32 v207, 3, v191
    v_add_u32 v207, v207, v188
    v_mul_u32_u24 v207, 0x300, v207
    v_lshlrev_b32 v208, 5, v190
    v_add_u32 v207, v207, v208
    v_lshlrev_b32 v208, 3, v189
    v_add_u32 v207, v207, v208
    v_add_u32 v207, 0x15db0, v207
    s_and_b32 s14, s40, 1
    s_mul_i32 s15, s14, 6
    s_add_u32 s2, s15, 0
    v_xor_b32 v208, s2, v188
    v_lshlrev_b32 v208, 6, v208
    v_add_u32 v192, v207, v208
    buffer_load_dwordx4 v116, s[16:19], 0 offen offset:3200 lds
    s_add_u32 s2, s15, 1
    v_xor_b32 v208, s2, v188
    v_lshlrev_b32 v208, 6, v208
    v_add_u32 v193, v207, v208
    s_add_u32 s2, s15, 2
    v_xor_b32 v208, s2, v188
    v_lshlrev_b32 v208, 6, v208
    v_add_u32 v194, v207, v208
    s_add_u32 s2, s15, 3
    v_xor_b32 v208, s2, v188
    v_lshlrev_b32 v208, 6, v208
    v_add_u32 v195, v207, v208
    s_add_u32 s2, s15, 4
    v_xor_b32 v208, s2, v188
    v_lshlrev_b32 v208, 6, v208
    s_add_u32 s66, s40, 10
    s_mul_i32 s67, s66, s77
    s_add_u32 s67, s67, s56
    s_add_u32 s16, s4, s67
    s_addc_u32 s17, s5, 0
    s_lshr_b32 s67, s66, 1
    s_mul_i32 s62, s67, 0x2120
    s_and_b32 s67, s67, 3
    s_lshl_b32 s67, s67, 3
    s_add_u32 s62, s62, s67
    s_and_b32 s67, s66, 1
    s_mul_i32 s67, s67, 0x1080
    s_add_u32 m0, s62, s67
    s_nop 0
    buffer_load_dwordx4 v112, s[16:19], 0 offen lds
    v_add_u32 v196, v207, v208
    s_add_u32 s2, s15, 5
    v_xor_b32 v208, s2, v188
    v_lshlrev_b32 v208, 6, v208
    v_add_u32 v197, v207, v208
    v_lshlrev_b32 v207, 2, v191
    v_add_u32 v207, v207, v188
    v_mul_u32_u24 v207, 0xc0, v207
    v_lshlrev_b32 v208, 5, v190
    v_add_u32 v207, v207, v208
    v_and_b32 v208, 1, v189
    buffer_load_dwordx4 v113, s[16:19], 0 offen offset:1024 lds
    v_lshlrev_b32 v208, 4, v208
    v_add_u32 v207, v207, v208
    v_and_b32 v208, 2, v189
    v_lshlrev_b32 v208, 2, v208
    v_add_u32 v207, v207, v208
    s_mul_i32 s15, s14, 0x3000
    s_add_u32 s15, s15, 0x15db0
    v_add_u32_e64 v198, s15, v207
    s_mul_i32 s60, s40, 0xc00
    v_add_u32 v207, 0x15830, v1
    ds_write_b128 v207, v[112:115]
    buffer_load_dwordx4 v114, s[16:19], 0 offen offset:2048 lds
    v_add_u32 v208, 0x80, v116
    ds_write_b32 v207, v208 offset:140
    v_pk_mov_b32 v[40:41], 0, 0
    v_pk_mov_b32 v[42:43], 0, 0
    v_pk_mov_b32 v[44:45], 0, 0
    v_pk_mov_b32 v[46:47], 0, 0
    v_pk_mov_b32 v[48:49], 0, 0
    v_pk_mov_b32 v[50:51], 0, 0
    v_pk_mov_b32 v[52:53], 0, 0
    v_pk_mov_b32 v[54:55], 0, 0
    buffer_load_dwordx4 v115, s[16:19], 0 offen offset:3072 lds
    v_pk_mov_b32 v[56:57], 0, 0
    v_pk_mov_b32 v[58:59], 0, 0
    v_pk_mov_b32 v[60:61], 0, 0
    v_pk_mov_b32 v[62:63], 0, 0
    v_pk_mov_b32 v[64:65], 0, 0
    v_pk_mov_b32 v[66:67], 0, 0
    v_pk_mov_b32 v[68:69], 0, 0
    v_pk_mov_b32 v[70:71], 0, 0
    v_pk_mov_b32 v[72:73], 0, 0
    v_pk_mov_b32 v[74:75], 0, 0
    v_pk_mov_b32 v[76:77], 0, 0
    v_pk_mov_b32 v[78:79], 0, 0
    v_pk_mov_b32 v[80:81], 0, 0
    v_pk_mov_b32 v[82:83], 0, 0
    buffer_load_dwordx4 v116, s[16:19], 0 offen offset:3200 lds
    v_pk_mov_b32 v[84:85], 0, 0
    v_pk_mov_b32 v[86:87], 0, 0
    s_add_u32 s66, s40, 3
    s_and_b32 s66, s66, 3
    s_lshl_b32 s66, s66, 3
    s_mul_i32 s42, s40, 0x2120
    s_add_u32 s42, s42, s66
    s_lshl_b32 s45, s40, 1
    s_add_u32 s45, s45, 14
    s_mul_i32 s67, s45, s77
    s_add_u32 s62, s67, s56
    s_add_u32 s16, s4, s62
    s_addc_u32 s17, s5, 0
    s_add_u32 s28, s16, s77
    s_addc_u32 s29, s17, s3
    s_mov_b32 s31, 0x20000
    s_add_u32 s43, s67, s0
    s_and_b32 s62, s77, s3
    s_add_u32 s43, s43, s62
    s_add_u32 s43, s43, s69
    s_sub_u32 s45, s45, 8
    s_add_u32 s45, s45, 8
    s_cmp_lt_u32 s45, s68
    s_cselect_b32 s30, 0x18c80, 0
    s_cselect_b32 s6, 0x3000000, 0
    s_cmp_lt_u32 s45, s44
    s_cselect_b32 s18, 0x18c80, 0
    s_waitcnt lgkmcnt(0)
    s_barrier
    s_add_u32 m0, s65, 0x15db0
    s_add_u32 s61, s65, 0
    buffer_load_dwordx4 v120, s[20:23], s61 offen lds
    ds_read2_b32 a[144:145], v4 offset0:0 offset1:1
    ds_read2_b32 a[146:147], v4 offset0:8 offset1:9
    ds_read2_b32 a[148:149], v4 offset0:4 offset1:5
    ds_read2_b32 a[150:151], v4 offset0:12 offset1:13
    ds_read2_b32 a[160:161], v4 offset0:64 offset1:65
    ds_read2_b32 a[162:163], v4 offset0:72 offset1:73
    buffer_load_dwordx4 v121, s[20:23], s61 offen offset:1024 lds
    ds_read2_b32 a[164:165], v4 offset0:68 offset1:69
    ds_read2_b32 a[166:167], v4 offset0:76 offset1:77
    ds_read2_b32 a[176:177], v4 offset0:128 offset1:129
    ds_read2_b32 a[178:179], v4 offset0:136 offset1:137
    buffer_load_dwordx4 v122, s[20:23], s61 offen offset:2048 lds
    ds_read2_b32 a[180:181], v4 offset0:132 offset1:133
    ds_read2_b32 a[182:183], v4 offset0:140 offset1:141
    ds_read2_b32 a[192:193], v5 offset0:0 offset1:1
    ds_read2_b32 a[194:195], v5 offset0:8 offset1:9
    s_add_u32 m0, s65, 0x169b0
    s_add_u32 s61, s65, 0xc00
    buffer_load_dwordx4 v120, s[20:23], s61 offen lds
    ds_read2_b32 a[196:197], v5 offset0:4 offset1:5
    ds_read2_b32 a[198:199], v5 offset0:12 offset1:13
    ds_read2_b32 a[208:209], v5 offset0:64 offset1:65
    ds_read2_b32 a[210:211], v5 offset0:72 offset1:73
    buffer_load_dwordx4 v121, s[20:23], s61 offen offset:1024 lds
    ds_read2_b32 a[212:213], v5 offset0:68 offset1:69
    ds_read2_b32 a[214:215], v5 offset0:76 offset1:77
    ds_read2_b32 a[224:225], v5 offset0:128 offset1:129
    ds_read2_b32 a[226:227], v5 offset0:136 offset1:137
    ds_read2_b32 a[228:229], v5 offset0:132 offset1:133
    buffer_load_dwordx4 v122, s[20:23], s61 offen offset:2048 lds
    ds_read2_b32 a[230:231], v5 offset0:140 offset1:141
    ds_read2_b32 a[152:153], v4 offset0:32 offset1:33
    ds_read2_b32 a[154:155], v4 offset0:40 offset1:41
    ds_read2_b32 a[156:157], v4 offset0:36 offset1:37
    s_add_u32 m0, s65, 0x175b0
    s_add_u32 s61, s65, 0x1800
    buffer_load_dwordx4 v120, s[20:23], s61 offen lds
    ds_read2_b32 a[158:159], v4 offset0:44 offset1:45
    ds_read2_b32 a[168:169], v4 offset0:96 offset1:97
    ds_read2_b32 a[170:171], v4 offset0:104 offset1:105
    ds_read2_b32 a[172:173], v4 offset0:100 offset1:101
    buffer_load_dwordx4 v121, s[20:23], s61 offen offset:1024 lds
    ds_read2_b32 a[174:175], v4 offset0:108 offset1:109
    ds_read2_b32 a[184:185], v4 offset0:160 offset1:161
    ds_read2_b32 a[186:187], v4 offset0:168 offset1:169
    ds_read2_b32 a[188:189], v4 offset0:164 offset1:165
    buffer_load_dwordx4 v122, s[20:23], s61 offen offset:2048 lds
    ds_read2_b32 a[190:191], v4 offset0:172 offset1:173
    ds_read2_b32 a[200:201], v5 offset0:32 offset1:33
    ds_read2_b32 a[202:203], v5 offset0:40 offset1:41
    ds_read2_b32 a[204:205], v5 offset0:36 offset1:37
    ds_read2_b32 a[206:207], v5 offset0:44 offset1:45
    s_add_u32 m0, s65, 0x181b0
    s_add_u32 s61, s65, 0x2400
    buffer_load_dwordx4 v120, s[20:23], s61 offen lds
    ds_read2_b32 a[216:217], v5 offset0:96 offset1:97
    ds_read2_b32 a[218:219], v5 offset0:104 offset1:105
    ds_read2_b32 a[220:221], v5 offset0:100 offset1:101
    ds_read2_b32 a[222:223], v5 offset0:108 offset1:109
    buffer_load_dwordx4 v121, s[20:23], s61 offen offset:1024 lds
    ds_read2_b32 a[232:233], v5 offset0:160 offset1:161
    ds_read2_b32 a[234:235], v5 offset0:168 offset1:169
    ds_read2_b32 a[236:237], v5 offset0:164 offset1:165
    ds_read2_b32 a[238:239], v5 offset0:172 offset1:173
    s_waitcnt vmcnt(16)
    s_barrier
    ds_read_b64 v[12:13], v2
    ds_read_b64 v[14:15], v2 offset:1056
    ds_read_b64 v[16:17], v2 offset:576
    ds_read_b64 v[18:19], v2 offset:1632
    ds_read_b64 v[20:21], v2 offset:96
    ds_read_b64 v[22:23], v2 offset:1152
    ds_read_b64 v[24:25], v2 offset:672
    ds_read_b64 v[26:27], v2 offset:1728
    ds_read_b64 v[28:29], v2 offset:192
    ds_read_b64 v[30:31], v2 offset:1248
    ds_read_b64 v[128:129], v2 offset:8
    ds_read_b64 v[130:131], v2 offset:1064
    ds_read_b64 v[132:133], v2 offset:584
    ds_read_b64 v[134:135], v2 offset:1640
    s_waitcnt lgkmcnt(4)
    v_smfmac_f32_16x16x64_bf16 v[40:43], a[144:147], v[12:19], v6
    ds_read_b64 v[136:137], v2 offset:104
    ds_read_b64 v[138:139], v2 offset:1160
    ds_read_b64 v[140:141], v2 offset:680
    v_smfmac_f32_16x16x64_bf16 v[44:47], a[144:147], v[16:23], v6
    ds_read_b64 v[142:143], v2 offset:1736
    ds_read_b64 v[144:145], v2 offset:200
    ds_read_b64 v[146:147], v2 offset:1256
    v_smfmac_f32_16x16x64_bf16 v[40:43], a[148:151], v[20:27], v6
    ds_read_b64 v[148:149], v2 offset:16
    ds_read_b64 v[150:151], v2 offset:1072
    buffer_load_dwordx4 v122, s[20:23], s61 offen offset:2048 lds
    v_smfmac_f32_16x16x64_bf16 v[44:47], a[148:151], v[24:31], v6
    ds_read_b64 v[152:153], v2 offset:592
    ds_read_b64 v[154:155], v2 offset:1648
    s_add_u32 m0, s65, 0x18db0
    s_add_u32 s61, s65, 0x3000
    buffer_load_dwordx4 v120, s[20:23], s61 offen lds
    s_waitcnt lgkmcnt(4)
    v_smfmac_f32_16x16x64_bf16 v[48:51], a[160:163], v[128:135], v6
    ds_read_b64 v[156:157], v2 offset:112
    ds_read_b64 v[158:159], v2 offset:1168
    ds_read_b64 v[160:161], v2 offset:688
    v_smfmac_f32_16x16x64_bf16 v[52:55], a[160:163], v[132:139], v6
    ds_read_b64 v[162:163], v2 offset:1744
    ds_read_b64 v[164:165], v2 offset:208
    ds_read_b64 v[166:167], v2 offset:1264
    v_smfmac_f32_16x16x64_bf16 v[48:51], a[164:167], v[136:143], v6
    ds_read_b64 v[12:13], v2 offset:24
    ds_read_b64 v[14:15], v2 offset:1080
    buffer_load_dwordx4 v121, s[20:23], s61 offen offset:1024 lds
    v_smfmac_f32_16x16x64_bf16 v[52:55], a[164:167], v[140:147], v6
    ds_read_b64 v[16:17], v2 offset:600
    ds_read_b64 v[18:19], v2 offset:1656
    buffer_load_dwordx4 v122, s[20:23], s61 offen offset:2048 lds
    s_waitcnt lgkmcnt(4)
    v_smfmac_f32_16x16x64_bf16 v[56:59], a[176:179], v[148:155], v6
    ds_read_b64 v[20:21], v2 offset:120
    ds_read_b64 v[22:23], v2 offset:1176
    ds_read_b64 v[24:25], v2 offset:696
    v_smfmac_f32_16x16x64_bf16 v[60:63], a[176:179], v[152:159], v6
    ds_read_b64 v[26:27], v2 offset:1752
    ds_read_b64 v[28:29], v2 offset:216
    ds_read_b64 v[30:31], v2 offset:1272
    v_smfmac_f32_16x16x64_bf16 v[56:59], a[180:183], v[156:163], v6
    ds_read_b64 v[128:129], v2 offset:32
    ds_read_b64 v[130:131], v2 offset:1088
    s_add_u32 m0, s65, 0x199b0
    s_add_u32 s61, s65, 0x3c00
    buffer_load_dwordx4 v120, s[20:23], s61 offen lds
    v_smfmac_f32_16x16x64_bf16 v[60:63], a[180:183], v[160:167], v6
    ds_read_b64 v[132:133], v2 offset:608
    ds_read_b64 v[134:135], v2 offset:1664
    buffer_load_dwordx4 v121, s[20:23], s61 offen offset:1024 lds
    s_waitcnt lgkmcnt(4)
    v_smfmac_f32_16x16x64_bf16 v[64:67], a[192:195], v[12:19], v6
    ds_read_b64 v[136:137], v2 offset:128
    ds_read_b64 v[138:139], v2 offset:1184
    ds_read_b64 v[140:141], v2 offset:704
    v_smfmac_f32_16x16x64_bf16 v[68:71], a[192:195], v[16:23], v6
    ds_read_b64 v[142:143], v2 offset:1760
    ds_read_b64 v[144:145], v2 offset:224
    ds_read_b64 v[146:147], v2 offset:1280
    v_smfmac_f32_16x16x64_bf16 v[64:67], a[196:199], v[20:27], v6
    ds_read_b64 v[148:149], v2 offset:40
    ds_read_b64 v[150:151], v2 offset:1096
    buffer_load_dwordx4 v122, s[20:23], s61 offen offset:2048 lds
    v_smfmac_f32_16x16x64_bf16 v[68:71], a[196:199], v[24:31], v6
    ds_read_b64 v[152:153], v2 offset:616
    ds_read_b64 v[154:155], v2 offset:1672
    s_mov_b32 m0, 0x15cb0
    s_nop 0
    buffer_load_dword v9, s[4:7], s43 offen lds
    s_waitcnt lgkmcnt(4)
    v_smfmac_f32_16x16x64_bf16 v[72:75], a[208:211], v[128:135], v6
    ds_read_b64 v[156:157], v2 offset:136
    ds_read_b64 v[158:159], v2 offset:1192
    ds_read_b64 v[160:161], v2 offset:712
    v_smfmac_f32_16x16x64_bf16 v[76:79], a[208:211], v[132:139], v6
    ds_read_b64 v[162:163], v2 offset:1768
    ds_read_b64 v[164:165], v2 offset:232
    ds_read_b64 v[166:167], v2 offset:1288
    v_smfmac_f32_16x16x64_bf16 v[72:75], a[212:215], v[136:143], v6
    s_waitcnt vmcnt(19)
    s_barrier
    ds_read_b64 v[12:13], v3
    ds_read_b64 v[14:15], v3 offset:1056
    v_smfmac_f32_16x16x64_bf16 v[76:79], a[212:215], v[140:147], v6
    ds_read_b64 v[16:17], v3 offset:576
    ds_read_b64 v[18:19], v3 offset:1632
    s_waitcnt lgkmcnt(4)
    v_smfmac_f32_16x16x64_bf16 v[80:83], a[224:227], v[148:155], v6
    ds_read_b64 v[20:21], v3 offset:96
    ds_read_b64 v[22:23], v3 offset:1152
    ds_read_b64 v[24:25], v3 offset:672
    v_smfmac_f32_16x16x64_bf16 v[84:87], a[224:227], v[152:159], v6
    ds_read_b64 v[26:27], v3 offset:1728
    ds_read_b64 v[28:29], v3 offset:192
    ds_read_b64 v[30:31], v3 offset:1248
    v_smfmac_f32_16x16x64_bf16 v[80:83], a[228:231], v[156:163], v6
    ds_read_b64 v[128:129], v3 offset:8
    ds_read_b64 v[130:131], v3 offset:1064
    v_smfmac_f32_16x16x64_bf16 v[84:87], a[228:231], v[160:167], v6
    ds_read_b64 v[132:133], v3 offset:584
    ds_read_b64 v[134:135], v3 offset:1640
    s_waitcnt lgkmcnt(4)
    v_smfmac_f32_16x16x64_bf16 v[40:43], a[152:155], v[12:19], v6
    ds_read_b64 v[136:137], v3 offset:104
    ds_read_b64 v[138:139], v3 offset:1160
    ds_read_b64 v[140:141], v3 offset:680
    v_smfmac_f32_16x16x64_bf16 v[44:47], a[152:155], v[16:23], v6
    ds_read_b64 v[142:143], v3 offset:1736
    ds_read_b64 v[144:145], v3 offset:200
    ds_read_b64 v[146:147], v3 offset:1256
    v_smfmac_f32_16x16x64_bf16 v[40:43], a[156:159], v[20:27], v6
    ds_read_b64 v[148:149], v3 offset:16
    ds_read_b64 v[150:151], v3 offset:1072
    v_smfmac_f32_16x16x64_bf16 v[44:47], a[156:159], v[24:31], v6
    ds_read_b64 v[152:153], v3 offset:592
    ds_read_b64 v[154:155], v3 offset:1648
    s_waitcnt lgkmcnt(4)
    v_smfmac_f32_16x16x64_bf16 v[48:51], a[168:171], v[128:135], v6
    ds_read_b64 v[156:157], v3 offset:112
    ds_read_b64 v[158:159], v3 offset:1168
    ds_read_b64 v[160:161], v3 offset:688
    v_smfmac_f32_16x16x64_bf16 v[52:55], a[168:171], v[132:139], v6
    ds_read_b64 v[162:163], v3 offset:1744
    ds_read_b64 v[164:165], v3 offset:208
    ds_read_b64 v[166:167], v3 offset:1264
    v_smfmac_f32_16x16x64_bf16 v[48:51], a[172:175], v[136:143], v6
    ds_read_b64 v[12:13], v3 offset:24
    ds_read_b64 v[14:15], v3 offset:1080
    v_smfmac_f32_16x16x64_bf16 v[52:55], a[172:175], v[140:147], v6
    ds_read_b64 v[16:17], v3 offset:600
    ds_read_b64 v[18:19], v3 offset:1656
    s_waitcnt lgkmcnt(4)
    v_smfmac_f32_16x16x64_bf16 v[56:59], a[184:187], v[148:155], v6
    ds_read_b64 v[20:21], v3 offset:120
    ds_read_b64 v[22:23], v3 offset:1176
    ds_read_b64 v[24:25], v3 offset:696
    v_smfmac_f32_16x16x64_bf16 v[60:63], a[184:187], v[152:159], v6
    ds_read_b64 v[26:27], v3 offset:1752
    ds_read_b64 v[28:29], v3 offset:216
    ds_read_b64 v[30:31], v3 offset:1272
    v_smfmac_f32_16x16x64_bf16 v[56:59], a[188:191], v[156:163], v6
    ds_read_b64 v[128:129], v3 offset:32
    ds_read_b64 v[130:131], v3 offset:1088
    v_smfmac_f32_16x16x64_bf16 v[60:63], a[188:191], v[160:167], v6
    ds_read_b64 v[132:133], v3 offset:608
    ds_read_b64 v[134:135], v3 offset:1664
    s_waitcnt lgkmcnt(4)
    v_smfmac_f32_16x16x64_bf16 v[64:67], a[200:203], v[12:19], v6
    ds_read_b64 v[136:137], v3 offset:128
    ds_read_b64 v[138:139], v3 offset:1184
    ds_read_b64 v[140:141], v3 offset:704
    v_smfmac_f32_16x16x64_bf16 v[68:71], a[200:203], v[16:23], v6
    ds_read_b64 v[142:143], v3 offset:1760
    ds_read_b64 v[144:145], v3 offset:224
    ds_read_b64 v[146:147], v3 offset:1280
    v_smfmac_f32_16x16x64_bf16 v[64:67], a[204:207], v[20:27], v6
    ds_read_b64 v[148:149], v3 offset:40
    ds_read_b64 v[150:151], v3 offset:1096
    v_smfmac_f32_16x16x64_bf16 v[68:71], a[204:207], v[24:31], v6
    ds_read_b64 v[152:153], v3 offset:616
    ds_read_b64 v[154:155], v3 offset:1672
    s_waitcnt lgkmcnt(4)
    v_smfmac_f32_16x16x64_bf16 v[72:75], a[216:219], v[128:135], v6
    ds_read_b64 v[156:157], v3 offset:136
    ds_read_b64 v[158:159], v3 offset:1192
    ds_read_b64 v[160:161], v3 offset:712
    v_smfmac_f32_16x16x64_bf16 v[76:79], a[216:219], v[132:139], v6
    ds_read_b64 v[162:163], v3 offset:1768
    ds_read_b64 v[164:165], v3 offset:232
    ds_read_b64 v[166:167], v3 offset:1288
    v_smfmac_f32_16x16x64_bf16 v[72:75], a[220:223], v[136:143], v6
    v_smfmac_f32_16x16x64_bf16 v[76:79], a[220:223], v[140:147], v6
    s_waitcnt lgkmcnt(0)
    v_smfmac_f32_16x16x64_bf16 v[80:83], a[232:235], v[148:155], v6
    v_smfmac_f32_16x16x64_bf16 v[84:87], a[232:235], v[152:159], v6
    v_smfmac_f32_16x16x64_bf16 v[80:83], a[236:239], v[156:163], v6
    v_smfmac_f32_16x16x64_bf16 v[84:87], a[236:239], v[160:167], v6
    v_pk_add_f32 v[12:13], v[40:41], v[42:43]
    v_pk_mul_f32 v[16:17], v[40:41], v[40:41]
    v_pk_fma_f32 v[16:17], v[42:43], v[42:43], v[16:17]
    v_pk_add_f32 v[14:15], v[44:45], v[46:47]
    v_pk_mul_f32 v[18:19], v[44:45], v[44:45]
    v_pk_fma_f32 v[18:19], v[46:47], v[46:47], v[18:19]
    v_pk_add_f32 v[12:13], v[12:13], v[48:49]
    v_pk_fma_f32 v[16:17], v[48:49], v[48:49], v[16:17]
    v_pk_add_f32 v[12:13], v[12:13], v[50:51]
    v_pk_fma_f32 v[16:17], v[50:51], v[50:51], v[16:17]
    v_pk_add_f32 v[14:15], v[14:15], v[52:53]
    v_pk_fma_f32 v[18:19], v[52:53], v[52:53], v[18:19]
    v_pk_add_f32 v[14:15], v[14:15], v[54:55]
    v_pk_fma_f32 v[18:19], v[54:55], v[54:55], v[18:19]
    v_pk_add_f32 v[12:13], v[12:13], v[56:57]
    v_pk_fma_f32 v[16:17], v[56:57], v[56:57], v[16:17]
    v_pk_add_f32 v[12:13], v[12:13], v[58:59]
    v_pk_fma_f32 v[16:17], v[58:59], v[58:59], v[16:17]
    v_pk_add_f32 v[14:15], v[14:15], v[60:61]
    v_pk_fma_f32 v[18:19], v[60:61], v[60:61], v[18:19]
    v_pk_add_f32 v[14:15], v[14:15], v[62:63]
    v_pk_fma_f32 v[18:19], v[62:63], v[62:63], v[18:19]
    v_pk_add_f32 v[12:13], v[12:13], v[64:65]
    v_pk_fma_f32 v[16:17], v[64:65], v[64:65], v[16:17]
    v_pk_add_f32 v[12:13], v[12:13], v[66:67]
    v_pk_fma_f32 v[16:17], v[66:67], v[66:67], v[16:17]
    v_pk_add_f32 v[14:15], v[14:15], v[68:69]
    v_pk_fma_f32 v[18:19], v[68:69], v[68:69], v[18:19]
    v_pk_add_f32 v[14:15], v[14:15], v[70:71]
    v_pk_fma_f32 v[18:19], v[70:71], v[70:71], v[18:19]
    v_pk_add_f32 v[12:13], v[12:13], v[72:73]
    v_pk_fma_f32 v[16:17], v[72:73], v[72:73], v[16:17]
    v_pk_add_f32 v[12:13], v[12:13], v[74:75]
    v_pk_fma_f32 v[16:17], v[74:75], v[74:75], v[16:17]
    v_pk_add_f32 v[14:15], v[14:15], v[76:77]
    v_pk_fma_f32 v[18:19], v[76:77], v[76:77], v[18:19]
    v_pk_add_f32 v[14:15], v[14:15], v[78:79]
    v_pk_fma_f32 v[18:19], v[78:79], v[78:79], v[18:19]
    v_pk_add_f32 v[12:13], v[12:13], v[80:81]
    v_pk_fma_f32 v[16:17], v[80:81], v[80:81], v[16:17]
    v_pk_add_f32 v[12:13], v[12:13], v[82:83]
    v_pk_fma_f32 v[16:17], v[82:83], v[82:83], v[16:17]
    v_pk_add_f32 v[14:15], v[14:15], v[84:85]
    v_pk_fma_f32 v[18:19], v[84:85], v[84:85], v[18:19]
    v_pk_add_f32 v[14:15], v[14:15], v[86:87]
    v_pk_fma_f32 v[18:19], v[86:87], v[86:87], v[18:19]
    v_add_f32 v12, v12, v13
    v_add_f32 v13, v14, v15
    v_add_f32 v14, v16, v17
    v_add_f32 v15, v18, v19
    v_add_u32_e64 v9, s50, v1
    ds_write_b128 v9, v[12:15]
    s_nop 1
    v_add_u32 v9, 0x14830, v1
    s_waitcnt vmcnt(1) lgkmcnt(0)
    s_barrier
    ds_read_b128 v[12:15], v9
    ds_read_b128 v[16:19], v9 offset:1024
    ds_read_b128 v[20:23], v9 offset:2048
    ds_read_b128 v[24:27], v9 offset:3072
    ds_read_b64_tr_b16 a[0:1], v192
    ds_read_b64_tr_b16 a[2:3], v192 offset:3072
    ds_read_b64_tr_b16 a[4:5], v192 offset:12288
    ds_read_b64_tr_b16 a[6:7], v192 offset:15360
    ds_read_b64_tr_b16 a[8:9], v192 offset:24576
    ds_read_b64_tr_b16 a[10:11], v192 offset:27648
    ds_read_b64_tr_b16 a[12:13], v192 offset:36864
    ds_read_b64_tr_b16 a[14:15], v192 offset:39936
    s_mov_b32 m0, s42
    s_nop 0
    buffer_load_dwordx4 v112, s[16:19], 0 offen lds
    buffer_load_dwordx4 v113, s[16:19], 0 offen offset:1024 lds
    ds_read_b64_tr_b16 a[16:17], v192 offset:49152
    ds_read_b64_tr_b16 a[18:19], v192 offset:52224
    ds_read_b64_tr_b16 a[20:21], v192 offset:61440
    ds_read_b64_tr_b16 a[22:23], v192 offset:64512
    ds_read_b64_tr_b16 a[24:25], v193
    ds_read_b64_tr_b16 a[26:27], v193 offset:3072
    ds_read_b64_tr_b16 a[28:29], v193 offset:12288
    ds_read_b64_tr_b16 a[30:31], v193 offset:15360
    ds_read_b64_tr_b16 a[32:33], v193 offset:24576
    ds_read_b64_tr_b16 a[34:35], v193 offset:27648
    s_waitcnt lgkmcnt(15)
    v_pk_add_f32 v[12:13], v[12:13], v[16:17]
    buffer_load_dwordx4 v114, s[16:19], 0 offen offset:2048 lds
    ds_read_b64_tr_b16 a[36:37], v193 offset:36864
    ds_read_b64_tr_b16 a[38:39], v193 offset:39936
    ds_read_b64_tr_b16 a[40:41], v193 offset:49152
    ds_read_b64_tr_b16 a[42:43], v193 offset:52224
    v_pk_add_f32 v[14:15], v[14:15], v[18:19]
    ds_read_b64_tr_b16 a[44:45], v193 offset:61440
    ds_read_b64_tr_b16 a[46:47], v193 offset:64512
    ds_read_b64_tr_b16 a[48:49], v194
    v_pk_add_f32 v[20:21], v[20:21], v[24:25]
    ds_read_b64_tr_b16 a[50:51], v194 offset:3072
    ds_read_b64_tr_b16 a[52:53], v194 offset:12288
    buffer_load_dwordx4 v115, s[16:19], 0 offen offset:3072 lds
    ds_read_b64_tr_b16 a[54:55], v194 offset:15360
    ds_read_b64_tr_b16 a[56:57], v194 offset:24576
    v_pk_add_f32 v[22:23], v[22:23], v[26:27]
    ds_read_b64_tr_b16 a[58:59], v194 offset:27648
    ds_read_b64_tr_b16 a[60:61], v194 offset:36864
    ds_read_b64_tr_b16 a[62:63], v194 offset:39936
    v_pk_add_f32 v[12:13], v[12:13], v[20:21]
    ds_read_b64_tr_b16 a[64:65], v194 offset:49152
    ds_read_b64_tr_b16 a[66:67], v194 offset:52224
    ds_read_b64_tr_b16 a[68:69], v194 offset:61440
    v_pk_add_f32 v[14:15], v[14:15], v[22:23]
    buffer_load_dwordx4 v116, s[16:19], 0 offen offset:3200 lds
    ds_read_b64_tr_b16 a[70:71], v194 offset:64512
    ds_read_b64_tr_b16 a[72:73], v195
    ds_read_b64_tr_b16 a[74:75], v195 offset:3072
    ds_read_b64_tr_b16 a[76:77], v195 offset:12288
    v_pk_mul_f32 v[12:13], v[12:13], s[36:37]
    ds_read_b64_tr_b16 a[78:79], v195 offset:15360
    ds_read_b64_tr_b16 a[80:81], v195 offset:24576
    ds_read_b64_tr_b16 a[82:83], v195 offset:27648
    v_pk_mul_f32 v[14:15], v[14:15], s[36:37]
    ds_read_b64_tr_b16 a[84:85], v195 offset:36864
    ds_read_b64_tr_b16 a[86:87], v195 offset:39936
    s_add_u32 m0, s42, 0x1080
    s_nop 0
    buffer_load_dwordx4 v112, s[28:31], 0 offen lds
    ds_read_b64_tr_b16 a[88:89], v195 offset:49152
    ds_read_b64_tr_b16 a[90:91], v195 offset:52224
    ds_read_b64_tr_b16 a[92:93], v195 offset:61440
    ds_read_b64_tr_b16 a[94:95], v195 offset:64512
    v_pk_fma_f32 v[14:15], v[12:13], v[12:13], v[14:15] neg_lo:[1,0,0] neg_hi:[1,0,0]
    ds_read_b64_tr_b16 a[96:97], v196
    ds_read_b64_tr_b16 a[98:99], v196 offset:3072
    ds_read_b64_tr_b16 a[100:101], v196 offset:12288
    v_max_f32 v14, 0, v14
    ds_read_b64_tr_b16 a[102:103], v196 offset:15360
    buffer_load_dwordx4 v113, s[28:31], 0 offen offset:1024 lds
    ds_read_b64_tr_b16 a[104:105], v196 offset:24576
    ds_read_b64_tr_b16 a[106:107], v196 offset:27648
    ds_read_b64_tr_b16 a[108:109], v196 offset:36864
    v_max_f32_e64 v15, 0, v15
    ds_read_b64_tr_b16 a[110:111], v196 offset:39936
    ds_read_b64_tr_b16 a[112:113], v196 offset:49152
    ds_read_b64_tr_b16 a[114:115], v196 offset:52224
    v_pk_add_f32 v[14:15], v[14:15], s[38:39]
    ds_read_b64_tr_b16 a[116:117], v196 offset:61440
    ds_read_b64_tr_b16 a[118:119], v196 offset:64512
    ds_read_b64_tr_b16 a[120:121], v197
    v_rsq_f32_e64 v14, v14
    buffer_load_dwordx4 v114, s[28:31], 0 offen offset:2048 lds
    ds_read_b64_tr_b16 a[122:123], v197 offset:3072
    ds_read_b64_tr_b16 a[124:125], v197 offset:12288
    ds_read_b64_tr_b16 a[126:127], v197 offset:15360
    ds_read_b64_tr_b16 a[128:129], v197 offset:24576
    ds_read_b64_tr_b16 a[130:131], v197 offset:27648
    v_rsq_f32_e64 v15, v15
    ds_read_b64_tr_b16 a[132:133], v197 offset:36864
    ds_read_b64_tr_b16 a[134:135], v197 offset:39936
    ds_read_b64_tr_b16 a[136:137], v197 offset:49152
    ds_read_b64_tr_b16 a[138:139], v197 offset:52224
    buffer_load_dwordx4 v115, s[28:31], 0 offen offset:3072 lds
    ds_read_b64_tr_b16 a[140:141], v197 offset:61440
    v_pk_mul_f32 v[28:29], v[14:15], s[34:35]
    ds_read_b64_tr_b16 a[142:143], v197 offset:64512
    v_pk_mul_f32 v[30:31], v[12:13], v[28:29] neg_lo:[1,0] neg_hi:[1,0]
    v_pk_fma_f32 v[40:41], v[40:41], v[28:29], v[30:31] op_sel:[0,0,0] op_sel_hi:[1,0,0]
    v_pk_fma_f32 v[42:43], v[42:43], v[28:29], v[30:31] op_sel:[0,0,0] op_sel_hi:[1,0,0]
    v_pk_fma_f32 v[44:45], v[44:45], v[28:29], v[30:31] op_sel:[0,1,1] op_sel_hi:[1,1,1]
    v_pk_fma_f32 v[46:47], v[46:47], v[28:29], v[30:31] op_sel:[0,1,1] op_sel_hi:[1,1,1]
    v_pk_fma_f32 v[48:49], v[48:49], v[28:29], v[30:31] op_sel:[0,0,0] op_sel_hi:[1,0,0]
    v_pk_fma_f32 v[50:51], v[50:51], v[28:29], v[30:31] op_sel:[0,0,0] op_sel_hi:[1,0,0]
    v_pk_fma_f32 v[52:53], v[52:53], v[28:29], v[30:31] op_sel:[0,1,1] op_sel_hi:[1,1,1]
    v_pk_fma_f32 v[54:55], v[54:55], v[28:29], v[30:31] op_sel:[0,1,1] op_sel_hi:[1,1,1]
    v_pk_fma_f32 v[56:57], v[56:57], v[28:29], v[30:31] op_sel:[0,0,0] op_sel_hi:[1,0,0]
    buffer_load_dwordx4 v116, s[28:31], 0 offen offset:3200 lds
    v_pk_fma_f32 v[58:59], v[58:59], v[28:29], v[30:31] op_sel:[0,0,0] op_sel_hi:[1,0,0]
    v_pk_fma_f32 v[60:61], v[60:61], v[28:29], v[30:31] op_sel:[0,1,1] op_sel_hi:[1,1,1]
    v_pk_fma_f32 v[62:63], v[62:63], v[28:29], v[30:31] op_sel:[0,1,1] op_sel_hi:[1,1,1]
    v_pk_fma_f32 v[64:65], v[64:65], v[28:29], v[30:31] op_sel:[0,0,0] op_sel_hi:[1,0,0]
    v_pk_fma_f32 v[66:67], v[66:67], v[28:29], v[30:31] op_sel:[0,0,0] op_sel_hi:[1,0,0]
    v_pk_fma_f32 v[68:69], v[68:69], v[28:29], v[30:31] op_sel:[0,1,1] op_sel_hi:[1,1,1]
    v_pk_fma_f32 v[70:71], v[70:71], v[28:29], v[30:31] op_sel:[0,1,1] op_sel_hi:[1,1,1]
    v_pk_fma_f32 v[72:73], v[72:73], v[28:29], v[30:31] op_sel:[0,0,0] op_sel_hi:[1,0,0]
    v_pk_fma_f32 v[74:75], v[74:75], v[28:29], v[30:31] op_sel:[0,0,0] op_sel_hi:[1,0,0]
    v_pk_fma_f32 v[76:77], v[76:77], v[28:29], v[30:31] op_sel:[0,1,1] op_sel_hi:[1,1,1]
    v_pk_fma_f32 v[78:79], v[78:79], v[28:29], v[30:31] op_sel:[0,1,1] op_sel_hi:[1,1,1]
    v_pk_fma_f32 v[80:81], v[80:81], v[28:29], v[30:31] op_sel:[0,0,0] op_sel_hi:[1,0,0]
    v_pk_fma_f32 v[82:83], v[82:83], v[28:29], v[30:31] op_sel:[0,0,0] op_sel_hi:[1,0,0]
    v_pk_fma_f32 v[84:85], v[84:85], v[28:29], v[30:31] op_sel:[0,1,1] op_sel_hi:[1,1,1]
    v_pk_fma_f32 v[86:87], v[86:87], v[28:29], v[30:31] op_sel:[0,1,1] op_sel_hi:[1,1,1]
    v_cvt_pk_bf16_f32 v40, v40, v41
    v_cvt_pk_bf16_f32 v41, v42, v43
    v_cvt_pk_bf16_f32 v42, v48, v49
    v_cvt_pk_bf16_f32 v43, v50, v51
    v_cvt_pk_bf16_f32 v44, v44, v45
    v_cvt_pk_bf16_f32 v45, v46, v47
    v_cvt_pk_bf16_f32 v46, v52, v53
    v_cvt_pk_bf16_f32 v47, v54, v55
    v_cvt_pk_bf16_f32 v56, v56, v57
    v_cvt_pk_bf16_f32 v57, v58, v59
    v_cvt_pk_bf16_f32 v58, v64, v65
    v_cvt_pk_bf16_f32 v59, v66, v67
    v_cvt_pk_bf16_f32 v60, v60, v61
    v_cvt_pk_bf16_f32 v61, v62, v63
    v_cvt_pk_bf16_f32 v62, v68, v69
    v_cvt_pk_bf16_f32 v63, v70, v71
    v_cvt_pk_bf16_f32 v72, v72, v73
    v_cvt_pk_bf16_f32 v73, v74, v75
    v_cvt_pk_bf16_f32 v74, v80, v81
    v_cvt_pk_bf16_f32 v75, v82, v83
    v_cvt_pk_bf16_f32 v76, v76, v77
    v_cvt_pk_bf16_f32 v77, v78, v79
    v_cvt_pk_bf16_f32 v78, v84, v85
    v_cvt_pk_bf16_f32 v79, v86, v87
    v_add_u32 v2, 0x8480, v2
    v_subrev_u32 v11, 0xe7e0, v2
    v_min_u32 v2, v2, v11
    v_add_u32 v3, 0x8480, v3
    v_subrev_u32 v11, 0xe7e0, v3
    v_min_u32 v3, v3, v11
    v_add_u32 v0, s46, v1
    s_mov_b32 s20, s10
    s_mov_b32 s21, s11
    s_mov_b32 s22, 0x12000
    s_mov_b32 s23, 0x20000
    s_waitcnt lgkmcnt(0)
    s_barrier
    s_add_u32 m0, s60, 0x15db0
    s_add_u32 s61, s60, 0
    buffer_load_dwordx4 v1, s[20:23], s61 offen lds
    ds_write_b128 v7, v[40:43]
    ds_write_b128 v7, v[44:47] offset:32
    buffer_load_dwordx4 v1, s[20:23], s61 offen offset:1024 lds
    ds_write_b128 v7, v[56:59] offset:512
    buffer_load_dwordx4 v1, s[20:23], s61 offen offset:2048 lds
    ds_write_b128 v7, v[60:63] offset:544
    s_add_u32 m0, s60, 0x18db0
    s_add_u32 s61, s60, 0x9000
    buffer_load_dwordx4 v1, s[20:23], s61 offen lds
    ds_write_b128 v7, v[72:75] offset:1024
    ds_write_b128 v7, v[76:79] offset:1056
    buffer_load_dwordx4 v1, s[20:23], s61 offen offset:1024 lds
    s_waitcnt lgkmcnt(0)
    s_barrier
    ds_read_b128 v[88:91], v0
    ds_read_b128 v[92:95], v0 offset:1024
    ds_read_b128 v[96:99], v0 offset:2048
    ds_read_b128 v[100:103], v0 offset:3072
    ds_read_b128 v[104:107], v0 offset:4096
    ds_read_b128 v[108:111], v0 offset:5120
    buffer_load_dwordx4 v1, s[20:23], s61 offen offset:2048 lds
    v_pk_mov_b32 v[40:41], 0, 0
    v_pk_mov_b32 v[42:43], 0, 0
    v_pk_mov_b32 v[44:45], 0, 0
    v_pk_mov_b32 v[46:47], 0, 0
    v_pk_mov_b32 v[48:49], 0, 0
    v_pk_mov_b32 v[50:51], 0, 0
    v_pk_mov_b32 v[52:53], 0, 0
    v_pk_mov_b32 v[54:55], 0, 0
    v_pk_mov_b32 v[56:57], 0, 0
    v_pk_mov_b32 v[58:59], 0, 0
    v_pk_mov_b32 v[60:61], 0, 0
    v_pk_mov_b32 v[62:63], 0, 0
    v_mov_b32 v10, 0
    v_mov_b32_e64 v9, v198
    s_waitcnt lgkmcnt(5)
    v_mfma_f32_32x32x16_bf16 v[112:127], a[0:3], v[88:91], 0
    s_add_u32 m0, s60, 0x1bdb0
    s_add_u32 s61, s60, 0x3000
    buffer_load_dwordx4 v1, s[20:23], s61 offen lds
    s_waitcnt lgkmcnt(4)
    v_mfma_f32_32x32x16_bf16 v[112:127], a[4:7], v[92:95], v[112:127]
    buffer_load_dwordx4 v1, s[20:23], s61 offen offset:1024 lds
    s_waitcnt lgkmcnt(3)
    v_mfma_f32_32x32x16_bf16 v[112:127], a[8:11], v[96:99], v[112:127]
    buffer_load_dwordx4 v1, s[20:23], s61 offen offset:2048 lds
    s_waitcnt lgkmcnt(2)
    v_mfma_f32_32x32x16_bf16 v[112:127], a[12:15], v[100:103], v[112:127]
    s_add_u32 m0, s60, 0x1edb0
    s_add_u32 s61, s60, 0xc000
    buffer_load_dwordx4 v1, s[20:23], s61 offen lds
    s_waitcnt lgkmcnt(1)
    v_mfma_f32_32x32x16_bf16 v[112:127], a[16:19], v[104:107], v[112:127]
    buffer_load_dwordx4 v1, s[20:23], s61 offen offset:1024 lds
    s_waitcnt lgkmcnt(0)
    v_mfma_f32_32x32x16_bf16 v[112:127], a[20:23], v[108:111], v[112:127]
    buffer_load_dwordx4 v1, s[20:23], s61 offen offset:2048 lds
    s_nop 10
    v_pk_fma_f32 v[128:129], v[112:113], v[112:113], s[32:33]
    v_pk_fma_f32 v[130:131], v[114:115], v[114:115], s[32:33]
    v_pk_fma_f32 v[132:133], v[116:117], v[116:117], s[32:33]
    v_pk_fma_f32 v[134:135], v[118:119], v[118:119], s[32:33]
    v_pk_fma_f32 v[136:137], v[120:121], v[120:121], s[32:33]
    v_pk_fma_f32 v[138:139], v[122:123], v[122:123], s[32:33]
    v_pk_fma_f32 v[140:141], v[124:125], v[124:125], s[32:33]
    v_pk_fma_f32 v[142:143], v[126:127], v[126:127], s[32:33]
    v_pk_mul_f32 v[128:129], v[128:129], v[112:113] neg_lo:[1,0] neg_hi:[1,0]
    v_pk_mul_f32 v[130:131], v[130:131], v[114:115] neg_lo:[1,0] neg_hi:[1,0]
    v_pk_mul_f32 v[132:133], v[132:133], v[116:117] neg_lo:[1,0] neg_hi:[1,0]
    v_pk_mul_f32 v[134:135], v[134:135], v[118:119] neg_lo:[1,0] neg_hi:[1,0]
    v_pk_mul_f32 v[136:137], v[136:137], v[120:121] neg_lo:[1,0] neg_hi:[1,0]
    v_pk_mul_f32 v[138:139], v[138:139], v[122:123] neg_lo:[1,0] neg_hi:[1,0]
    v_pk_mul_f32 v[140:141], v[140:141], v[124:125] neg_lo:[1,0] neg_hi:[1,0]
    v_pk_mul_f32 v[142:143], v[142:143], v[126:127] neg_lo:[1,0] neg_hi:[1,0]
    v_mfma_f32_32x32x16_bf16 v[144:159], a[24:27], v[88:91], 0
    v_exp_f32 v128, v128
    v_exp_f32 v129, v129
    v_exp_f32 v130, v130
    v_mfma_f32_32x32x16_bf16 v[144:159], a[28:31], v[92:95], v[144:159]
    v_exp_f32 v131, v131
    v_exp_f32 v132, v132
    v_exp_f32 v133, v133
    v_mfma_f32_32x32x16_bf16 v[144:159], a[32:35], v[96:99], v[144:159]
    v_exp_f32 v134, v134
    v_exp_f32 v135, v135
    v_exp_f32 v136, v136
    v_mfma_f32_32x32x16_bf16 v[144:159], a[36:39], v[100:103], v[144:159]
    v_exp_f32 v137, v137
    v_exp_f32 v138, v138
    v_exp_f32 v139, v139
    v_mfma_f32_32x32x16_bf16 v[144:159], a[40:43], v[104:107], v[144:159]
    v_exp_f32 v140, v140
    v_exp_f32 v141, v141
    v_exp_f32 v142, v142
    v_mfma_f32_32x32x16_bf16 v[144:159], a[44:47], v[108:111], v[144:159]
    v_exp_f32 v143, v143
    v_pk_fma_f32 v[128:129], v[128:129], s[34:35], s[34:35]
    v_pk_fma_f32 v[130:131], v[130:131], s[34:35], s[34:35]
    v_pk_fma_f32 v[132:133], v[132:133], s[34:35], s[34:35]
    v_pk_fma_f32 v[134:135], v[134:135], s[34:35], s[34:35]
    v_pk_fma_f32 v[136:137], v[136:137], s[34:35], s[34:35]
    v_pk_fma_f32 v[138:139], v[138:139], s[34:35], s[34:35]
    v_pk_fma_f32 v[140:141], v[140:141], s[34:35], s[34:35]
    v_pk_fma_f32 v[142:143], v[142:143], s[34:35], s[34:35]
    v_rcp_f32 v128, v128
    v_rcp_f32 v129, v129
    v_rcp_f32 v130, v130
    v_rcp_f32 v131, v131
    v_rcp_f32 v132, v132
    v_rcp_f32 v133, v133
    v_rcp_f32 v134, v134
    v_rcp_f32 v135, v135
    s_waitcnt vmcnt(0)
    s_barrier
    ds_read2_b32 v[32:33], v4 offset0:0 offset1:1
    ds_read2_b32 v[34:35], v4 offset0:8 offset1:9
    ds_read2_b32 v[36:37], v4 offset0:4 offset1:5
    ds_read2_b32 v[38:39], v4 offset0:12 offset1:13
    ds_read_b64 v[12:13], v2
    ds_read_b64 v[14:15], v2 offset:1056
    ds_read_b64 v[16:17], v2 offset:576
    ds_read_b64 v[18:19], v2 offset:1632
    ds_read_b64 v[20:21], v2 offset:96
    ds_read_b64 v[22:23], v2 offset:1152
    ds_read_b64 v[24:25], v2 offset:672
    ds_read_b64 v[26:27], v2 offset:1728
    ds_read_b64 v[28:29], v2 offset:192
    ds_read_b64 v[30:31], v2 offset:1248
    v_rcp_f32 v136, v136
    v_rcp_f32 v137, v137
    v_rcp_f32 v138, v138
    v_rcp_f32 v139, v139
    ds_read_b64_tr_b16 a[144:145], v9
    ds_read_b64_tr_b16 a[146:147], v9 offset:1536
    ds_read_b64_tr_b16 a[148:149], v9 offset:64
    ds_read_b64_tr_b16 a[150:151], v9 offset:1600
    ds_read_b64_tr_b16 a[152:153], v9 offset:128
    ds_read_b64_tr_b16 a[154:155], v9 offset:1664
    ds_read_b64_tr_b16 a[156:157], v9 offset:3072
    ds_read_b64_tr_b16 a[158:159], v9 offset:4608
    ds_read_b64_tr_b16 a[160:161], v9 offset:3136
    ds_read_b64_tr_b16 a[162:163], v9 offset:4672
    v_rcp_f32 v140, v140
    v_rcp_f32 v141, v141
    v_rcp_f32 v142, v142
    v_rcp_f32_e64 v143, v143
    s_waitcnt lgkmcnt(10)
    v_smfmac_f32_16x16x64_bf16 v[40:43], v[32:35], v[12:19], v6
    ds_read_b64 v[12:13], v3
    ds_read_b64 v[14:15], v3 offset:1056
    v_smfmac_f32_16x16x64_bf16 v[44:47], v[32:35], v[16:23], v6
    ds_read2_b32 v[32:33], v4 offset0:32 offset1:33
    ds_read2_b32 v[34:35], v4 offset0:40 offset1:41
    ds_read_b64 v[16:17], v3 offset:576
    ds_read_b64 v[18:19], v3 offset:1632
    v_smfmac_f32_16x16x64_bf16 v[40:43], v[36:39], v[20:27], v6
    ds_read_b64 v[20:21], v3 offset:96
    ds_read_b64 v[22:23], v3 offset:1152
    v_smfmac_f32_16x16x64_bf16 v[44:47], v[36:39], v[24:31], v6
    ds_read2_b32 v[36:37], v4 offset0:36 offset1:37
    ds_read2_b32 v[38:39], v4 offset0:44 offset1:45
    ds_read_b64 v[24:25], v3 offset:672
    ds_read_b64 v[26:27], v3 offset:1728
    ds_read_b64 v[28:29], v3 offset:192
    ds_read_b64 v[30:31], v3 offset:1248
    ds_read_b64_tr_b16 a[164:165], v9 offset:3200
    ds_read_b64_tr_b16 a[166:167], v9 offset:4736
    ds_read_b64_tr_b16 a[168:169], v9 offset:6144
    ds_read_b64_tr_b16 a[170:171], v9 offset:7680
    ds_read_b64_tr_b16 a[172:173], v9 offset:6208
    ds_read_b64_tr_b16 a[174:175], v9 offset:7744
    ds_read_b64_tr_b16 a[176:177], v9 offset:6272
    ds_read_b64_tr_b16 a[178:179], v9 offset:7808
    ds_read_b64_tr_b16 a[180:181], v9 offset:9216
    ds_read_b64_tr_b16 a[182:183], v9 offset:10752
    v_pk_mul_f32 v[128:129], v[128:129], v[112:113]
    ds_read_b64_tr_b16 a[184:185], v9 offset:9280
    ds_read_b64_tr_b16 a[186:187], v9 offset:10816
    ds_read_b64_tr_b16 a[188:189], v9 offset:9344
    v_pk_mul_f32 v[130:131], v[130:131], v[114:115]
    ds_read_b64_tr_b16 a[190:191], v9 offset:10880
    ds_read_b64_tr_b16 a[192:193], v9 offset:24576
    ds_read_b64_tr_b16 a[194:195], v9 offset:26112
    v_pk_mul_f32 v[132:133], v[132:133], v[116:117]
    ds_read_b64_tr_b16 a[196:197], v9 offset:24640
    ds_read_b64_tr_b16 a[198:199], v9 offset:26176
    ds_read_b64_tr_b16 a[200:201], v9 offset:24704
    v_pk_mul_f32 v[134:135], v[134:135], v[118:119]
    ds_read_b64_tr_b16 a[202:203], v9 offset:26240
    ds_read_b64_tr_b16 a[204:205], v9 offset:27648
    ds_read_b64_tr_b16 a[206:207], v9 offset:29184
    v_pk_mul_f32 v[136:137], v[136:137], v[120:121]
    ds_read_b64_tr_b16 a[208:209], v9 offset:27712
    ds_read_b64_tr_b16 a[210:211], v9 offset:29248
    ds_read_b64_tr_b16 a[212:213], v9 offset:27776
    v_pk_mul_f32 v[138:139], v[138:139], v[122:123]
    ds_read_b64_tr_b16 a[214:215], v9 offset:29312
    ds_read_b64_tr_b16 a[216:217], v9 offset:30720
    ds_read_b64_tr_b16 a[218:219], v9 offset:32256
    v_pk_mul_f32 v[140:141], v[140:141], v[124:125]
    ds_read_b64_tr_b16 a[220:221], v9 offset:30784
    ds_read_b64_tr_b16 a[222:223], v9 offset:32320
    ds_read_b64_tr_b16 a[224:225], v9 offset:30848
    v_pk_mul_f32 v[142:143], v[142:143], v[126:127]
    ds_read_b64_tr_b16 a[226:227], v9 offset:32384
    ds_read_b64_tr_b16 a[228:229], v9 offset:33792
    ds_read_b64_tr_b16 a[230:231], v9 offset:35328
    v_pk_fma_f32 v[160:161], v[144:145], v[144:145], s[32:33]
    ds_read_b64_tr_b16 a[232:233], v9 offset:33856
    ds_read_b64_tr_b16 a[234:235], v9 offset:35392
    ds_read_b64_tr_b16 a[236:237], v9 offset:33920
    v_pk_fma_f32 v[162:163], v[146:147], v[146:147], s[32:33]
    ds_read_b64_tr_b16 a[238:239], v9 offset:35456
    v_pk_fma_f32 v[164:165], v[148:149], v[148:149], s[32:33]
    v_pk_fma_f32 v[166:167], v[150:151], v[150:151], s[32:33]
    v_pk_fma_f32 v[168:169], v[152:153], v[152:153], s[32:33]
    v_pk_fma_f32 v[170:171], v[154:155], v[154:155], s[32:33]
    v_pk_fma_f32 v[172:173], v[156:157], v[156:157], s[32:33]
    v_pk_fma_f32 v[174:175], v[158:159], v[158:159], s[32:33]
    v_pk_mul_f32 v[160:161], v[160:161], v[144:145] neg_lo:[1,0] neg_hi:[1,0]
    v_pk_mul_f32 v[162:163], v[162:163], v[146:147] neg_lo:[1,0] neg_hi:[1,0]
    v_pk_mul_f32 v[164:165], v[164:165], v[148:149] neg_lo:[1,0] neg_hi:[1,0]
    v_pk_mul_f32 v[166:167], v[166:167], v[150:151] neg_lo:[1,0] neg_hi:[1,0]
    v_pk_mul_f32 v[168:169], v[168:169], v[152:153] neg_lo:[1,0] neg_hi:[1,0]
    v_pk_mul_f32 v[170:171], v[170:171], v[154:155] neg_lo:[1,0] neg_hi:[1,0]
    v_pk_mul_f32 v[172:173], v[172:173], v[156:157] neg_lo:[1,0] neg_hi:[1,0]
    v_pk_mul_f32 v[174:175], v[174:175], v[158:159] neg_lo:[1,0] neg_hi:[1,0]
    v_mfma_f32_32x32x16_bf16 v[112:127], a[48:51], v[88:91], 0
    s_waitcnt lgkmcnt(0)
    s_barrier
    s_add_u32 m0, s60, 0x15db0
    s_add_u32 s61, s60, 0x6000
    buffer_load_dwordx4 v1, s[20:23], s61 offen lds
    v_smfmac_f32_16x16x64_bf16 v[40:43], v[32:35], v[12:19], v6
    ds_read2_b64 v[12:15], v2 offset0:1 offset1:133
    v_cvt_pk_bf16_f32 v128, v128, v129
    v_mfma_f32_32x32x16_bf16 v[112:127], a[52:55], v[92:95], v[112:127]
    buffer_load_dwordx4 v1, s[20:23], s61 offen offset:1024 lds
    v_cvt_pk_bf16_f32 v129, v130, v131
    v_exp_f32 v160, v160
    v_exp_f32 v161, v161
    v_smfmac_f32_16x16x64_bf16 v[44:47], v[32:35], v[16:23], v6
    ds_read2_b32 v[32:33], v4 offset0:64 offset1:65
    ds_read2_b32 v[34:35], v4 offset0:72 offset1:73
    v_mfma_f32_32x32x16_bf16 v[112:127], a[56:59], v[96:99], v[112:127]
    buffer_load_dwordx4 v1, s[20:23], s61 offen offset:2048 lds
    v_cvt_pk_bf16_f32 v130, v132, v133
    v_exp_f32 v162, v162
    v_exp_f32 v163, v163
    v_smfmac_f32_16x16x64_bf16 v[40:43], v[36:39], v[20:27], v6
    ds_read2_b64 v[16:19], v2 offset0:73 offset1:205
    ds_read2_b64 v[20:23], v2 offset0:13 offset1:145
    v_mfma_f32_32x32x16_bf16 v[112:127], a[60:63], v[100:103], v[112:127]
    s_add_u32 m0, s60, 0x18db0
    s_add_u32 s61, s60, 0xf000
    buffer_load_dwordx4 v1, s[20:23], s61 offen lds
    v_cvt_pk_bf16_f32 v131, v134, v135
    v_exp_f32_e64 v164, v164
    v_smfmac_f32_16x16x64_bf16 v[44:47], v[36:39], v[24:31], v6
    ds_read2_b32 v[36:37], v4 offset0:68 offset1:69
    ds_read2_b32 v[38:39], v4 offset0:76 offset1:77
    v_mfma_f32_32x32x16_bf16 v[112:127], a[64:67], v[104:107], v[112:127]
    ds_read2_b64 v[24:27], v2 offset0:85 offset1:217
    buffer_load_dwordx4 v1, s[20:23], s61 offen offset:1024 lds
    v_exp_f32 v165, v165
    v_exp_f32 v166, v166
    v_mfma_f32_32x32x16_bf16 v[112:127], a[68:71], v[108:111], v[112:127]
    ds_read2_b64 v[28:31], v2 offset0:25 offset1:157
    buffer_load_dwordx4 v1, s[20:23], s61 offen offset:2048 lds
    v_exp_f32 v167, v167
    v_exp_f32 v168, v168
    v_exp_f32 v169, v169
    v_exp_f32 v170, v170
    v_exp_f32 v171, v171
    v_exp_f32 v172, v172
    v_exp_f32 v173, v173
    v_exp_f32 v174, v174
    v_exp_f32_e64 v175, v175
    s_add_u32 s42, s42, 0x8480
    s_sub_u32 s61, s42, 0xe7e0
    s_min_u32 s42, s42, s61
    s_add_u32 s43, s43, s55
    s_add_u32 s16, s16, s55
    s_addc_u32 s17, s17, s3
    s_add_u32 s28, s28, s55
    s_addc_u32 s29, s29, s3
    s_add_u32 s20, s4, s1
    s_addc_u32 s21, s5, 0
    s_mov_b32 s22, 0x18c00
    s_add_u32 s24, s12, s1
    s_addc_u32 s25, s13, 0
    s_mov_b32 s26, 0
    s_sub_u32 s24, s24, s55
    s_subb_u32 s25, s25, s3
    s_and_b32 s62, s3, 0x18000
    s_add_u32 s24, s24, s62
    s_addc_u32 s25, s25, 0
    s_add_u32 s8, s24, s77
    s_addc_u32 s9, s25, s3
    s_mov_b32 s10, 0
    s_mov_b32 s11, 0x20000
    s_movk_i32 s12, 0x90
    s_mov_b32 s13, 0xffffe610
    v_mov_b32 v0, 0x40000
    v_mov_b32_e64 v11, 0
    v_pk_fma_f32 v[160:161], v[160:161], s[34:35], s[34:35]
    v_pk_fma_f32 v[162:163], v[162:163], s[34:35], s[34:35]
    v_pk_fma_f32 v[164:165], v[164:165], s[34:35], s[34:35]
    v_pk_fma_f32 v[166:167], v[166:167], s[34:35], s[34:35]
    v_pk_fma_f32 v[168:169], v[168:169], s[34:35], s[34:35]
    v_pk_fma_f32 v[170:171], v[170:171], s[34:35], s[34:35]
    v_pk_fma_f32 v[172:173], v[172:173], s[34:35], s[34:35]
    v_pk_fma_f32 v[174:175], v[174:175], s[34:35], s[34:35]
    v_mfma_f32_32x32x16_bf16 v[176:191], a[144:147], v[128:131], 0
    s_waitcnt lgkmcnt(0)
    v_cvt_pk_bf16_f32 v132, v136, v137
    v_cvt_pk_bf16_f32 v133, v138, v139
    v_cvt_pk_bf16_f32 v134, v140, v141
    v_cvt_pk_bf16_f32 v135, v142, v143
    v_rcp_f32 v160, v160
    v_smfmac_f32_16x16x64_bf16 v[48:51], v[32:35], v[12:19], v6
    ds_read2_b64 v[12:15], v3 offset0:1 offset1:133
    v_rcp_f32 v161, v161
    v_mfma_f32_32x32x16_bf16 v[192:207], a[148:151], v[128:131], 0
    v_rcp_f32 v162, v162
    v_rcp_f32 v163, v163
    v_rcp_f32 v164, v164
    v_smfmac_f32_16x16x64_bf16 v[52:55], v[32:35], v[16:23], v6
    ds_read2_b32 v[32:33], v4 offset0:96 offset1:97
    ds_read2_b32 v[34:35], v4 offset0:104 offset1:105
    v_mfma_f32_32x32x16_bf16 v[208:223], a[152:155], v[128:131], 0
    v_rcp_f32 v165, v165
    v_rcp_f32 v166, v166
    v_rcp_f32_e64 v167, v167
    v_smfmac_f32_16x16x64_bf16 v[48:51], v[36:39], v[20:27], v6
    ds_read2_b64 v[16:19], v3 offset0:73 offset1:205
    ds_read2_b64 v[20:23], v3 offset0:13 offset1:145
    v_mfma_f32_32x32x16_bf16 v[176:191], a[156:159], v[132:135], v[176:191]
    v_rcp_f32 v168, v168
    v_rcp_f32 v169, v169
    v_smfmac_f32_16x16x64_bf16 v[52:55], v[36:39], v[24:31], v6
    ds_read2_b32 v[36:37], v4 offset0:100 offset1:101
    ds_read2_b32 v[38:39], v4 offset0:108 offset1:109
    v_mfma_f32_32x32x16_bf16 v[192:207], a[160:163], v[132:135], v[192:207]
    ds_read2_b64 v[24:27], v3 offset0:85 offset1:217
    v_mfma_f32_32x32x16_bf16 v[208:223], a[164:167], v[132:135], v[208:223]
    ds_read2_b64 v[28:31], v3 offset0:25 offset1:157
    s_waitcnt vmcnt(0)
    s_barrier
    ds_read_b64_tr_b16 a[240:241], v9
    ds_read_b64_tr_b16 a[242:243], v9 offset:1536
    ds_read_b64_tr_b16 a[244:245], v9 offset:64
    ds_read_b64_tr_b16 a[246:247], v9 offset:1600
    ds_read_b64_tr_b16 a[248:249], v9 offset:128
    ds_read_b64_tr_b16 a[250:251], v9 offset:1664
    ds_read_b64_tr_b16 a[252:253], v9 offset:3072
    ds_read_b64_tr_b16 a[254:255], v9 offset:4608
    v_rcp_f32 v170, v170
    v_rcp_f32 v171, v171
    ds_read_b64_tr_b16 v[224:225], v9 offset:3136
    ds_read_b64_tr_b16 v[226:227], v9 offset:4672
    ds_read_b64_tr_b16 v[228:229], v9 offset:3200
    ds_read_b64_tr_b16 v[230:231], v9 offset:4736
    ds_read_b64_tr_b16 v[232:233], v9 offset:6144
    ds_read_b64_tr_b16 v[234:235], v9 offset:7680
    ds_read_b64_tr_b16 v[236:237], v9 offset:6208
    ds_read_b64_tr_b16 v[238:239], v9 offset:7744
    v_rcp_f32 v172, v172
    v_rcp_f32 v173, v173
    ds_read_b64_tr_b16 v[240:241], v9 offset:6272
    ds_read_b64_tr_b16 v[242:243], v9 offset:7808
    ds_read_b64_tr_b16 v[244:245], v9 offset:9216
    ds_read_b64_tr_b16 v[246:247], v9 offset:10752
    ds_read_b64_tr_b16 v[248:249], v9 offset:9280
    ds_read_b64_tr_b16 v[250:251], v9 offset:10816
    ds_read_b64_tr_b16 v[252:253], v9 offset:9344
    ds_read_b64_tr_b16 v[254:255], v9 offset:10880
    v_rcp_f32 v174, v174
    v_rcp_f32 v175, v175
    s_add_u32 s45, s45, 8
    s_cmp_lt_u32 s45, s68
    s_cselect_b32 s30, 0x18c80, 0
    s_cselect_b32 s6, 0x3000000, 0
    v_mov_b32 v9, 0
    s_waitcnt lgkmcnt(0)
    s_barrier
.p2align 6
L_loop:
    v_pk_mul_f32 v[160:161], v[160:161], v[144:145]
    v_pk_mul_f32 v[162:163], v[162:163], v[146:147]
    v_pk_mul_f32 v[164:165], v[164:165], v[148:149]
    v_pk_mul_f32 v[166:167], v[166:167], v[150:151]
    v_pk_mul_f32 v[168:169], v[168:169], v[152:153]
    v_pk_mul_f32 v[170:171], v[170:171], v[154:155]
    v_pk_mul_f32 v[172:173], v[172:173], v[156:157]
    v_pk_mul_f32 v[174:175], v[174:175], v[158:159]
    v_pk_fma_f32 v[128:129], v[112:113], v[112:113], s[32:33]
    v_pk_fma_f32 v[130:131], v[114:115], v[114:115], s[32:33]
    v_pk_fma_f32 v[132:133], v[116:117], v[116:117], s[32:33]
    v_pk_fma_f32 v[134:135], v[118:119], v[118:119], s[32:33]
    v_pk_fma_f32 v[136:137], v[120:121], v[120:121], s[32:33]
    v_pk_fma_f32 v[138:139], v[122:123], v[122:123], s[32:33]
    v_pk_fma_f32 v[140:141], v[124:125], v[124:125], s[32:33]
    v_pk_fma_f32 v[142:143], v[126:127], v[126:127], s[32:33]
    v_pk_mul_f32 v[128:129], v[128:129], v[112:113] neg_lo:[1,0] neg_hi:[1,0]
    v_pk_mul_f32 v[130:131], v[130:131], v[114:115] neg_lo:[1,0] neg_hi:[1,0]
    v_pk_mul_f32 v[132:133], v[132:133], v[116:117] neg_lo:[1,0] neg_hi:[1,0]
    v_pk_mul_f32 v[134:135], v[134:135], v[118:119] neg_lo:[1,0] neg_hi:[1,0]
    v_pk_mul_f32 v[136:137], v[136:137], v[120:121] neg_lo:[1,0] neg_hi:[1,0]
    v_pk_mul_f32 v[138:139], v[138:139], v[122:123] neg_lo:[1,0] neg_hi:[1,0]
    v_pk_mul_f32 v[140:141], v[140:141], v[124:125] neg_lo:[1,0] neg_hi:[1,0]
    v_pk_mul_f32 v[142:143], v[142:143], v[126:127] neg_lo:[1,0] neg_hi:[1,0]
    v_mfma_f32_32x32x16_bf16 v[144:159], a[72:75], v[88:91], 0
    s_waitcnt lgkmcnt(0)
    v_exp_f32 v128, v128
    v_exp_f32 v129, v129
    v_exp_f32 v130, v130
    v_smfmac_f32_16x16x64_bf16 v[48:51], v[32:35], v[12:19], v6
    ds_read2_b64 v[12:15], v2 offset0:2 offset1:134
    v_cvt_pk_bf16_f32 v160, v160, v161
    v_mfma_f32_32x32x16_bf16 v[144:159], a[76:79], v[92:95], v[144:159]
    ds_read_b128 v[64:67], v9
    ds_read_b128 v[68:71], v9 offset:3328
    v_exp_f32 v131, v131
    v_exp_f32 v132, v132
    v_smfmac_f32_16x16x64_bf16 v[52:55], v[32:35], v[16:23], v6
    ds_read2_b32 v[32:33], v4 offset0:128 offset1:129
    ds_read2_b32 v[34:35], v4 offset0:136 offset1:137
    v_mfma_f32_32x32x16_bf16 v[144:159], a[80:83], v[96:99], v[144:159]
    v_exp_f32 v133, v133
    v_exp_f32 v134, v134
    v_exp_f32_e64 v135, v135
    v_smfmac_f32_16x16x64_bf16 v[48:51], v[36:39], v[20:27], v6
    ds_read2_b64 v[16:19], v2 offset0:74 offset1:206
    ds_read2_b64 v[20:23], v2 offset0:14 offset1:146
    v_mfma_f32_32x32x16_bf16 v[144:159], a[84:87], v[100:103], v[144:159]
    v_exp_f32 v136, v136
    v_exp_f32 v137, v137
    v_exp_f32_e64 v138, v138
    v_smfmac_f32_16x16x64_bf16 v[52:55], v[36:39], v[24:31], v6
    ds_read2_b32 v[36:37], v4 offset0:132 offset1:133
    ds_read2_b32 v[38:39], v4 offset0:140 offset1:141
    v_mfma_f32_32x32x16_bf16 v[144:159], a[88:91], v[104:107], v[144:159]
    ds_read2_b64 v[24:27], v2 offset0:86 offset1:218
    v_cvt_pk_bf16_f32 v161, v162, v163
    v_exp_f32 v139, v139
    v_exp_f32 v140, v140
    v_mfma_f32_32x32x16_bf16 v[144:159], a[92:95], v[108:111], v[144:159]
    ds_read2_b64 v[28:31], v2 offset0:26 offset1:158
    ds_write_b128 v0, v[72:75] offset:64
    v_cvt_pk_bf16_f32 v162, v164, v165
    v_cvt_pk_bf16_f32 v163, v166, v167
    v_exp_f32 v141, v141
    v_exp_f32 v142, v142
    v_exp_f32_e64 v143, v143
    v_pk_fma_f32 v[128:129], v[128:129], s[34:35], s[34:35]
    v_pk_fma_f32 v[130:131], v[130:131], s[34:35], s[34:35]
    v_pk_fma_f32 v[132:133], v[132:133], s[34:35], s[34:35]
    v_pk_fma_f32 v[134:135], v[134:135], s[34:35], s[34:35]
    v_pk_fma_f32 v[136:137], v[136:137], s[34:35], s[34:35]
    v_pk_fma_f32 v[138:139], v[138:139], s[34:35], s[34:35]
    v_pk_fma_f32 v[140:141], v[140:141], s[34:35], s[34:35]
    v_pk_fma_f32 v[142:143], v[142:143], s[34:35], s[34:35]
    v_mfma_f32_32x32x16_bf16 v[176:191], a[168:171], v[160:163], v[176:191]
    s_waitcnt lgkmcnt(0)
    v_cvt_pk_bf16_f32 v164, v168, v169
    v_cvt_pk_bf16_f32 v165, v170, v171
    v_cvt_pk_bf16_f32 v166, v172, v173
    v_cvt_pk_bf16_f32 v167, v174, v175
    v_rcp_f32 v128, v128
    v_smfmac_f32_16x16x64_bf16 v[56:59], v[32:35], v[12:19], v6
    ds_read2_b64 v[12:15], v3 offset0:2 offset1:134
    v_rcp_f32 v129, v129
    v_mfma_f32_32x32x16_bf16 v[192:207], a[172:175], v[160:163], v[192:207]
    buffer_store_dwordx4 v[64:67], v11, s[24:27], 0 offen sc1 nt
    v_rcp_f32 v130, v130
    v_rcp_f32 v131, v131
    v_rcp_f32 v132, v132
    v_smfmac_f32_16x16x64_bf16 v[60:63], v[32:35], v[16:23], v6
    ds_read2_b32 v[32:33], v4 offset0:160 offset1:161
    ds_read2_b32 v[34:35], v4 offset0:168 offset1:169
    v_mfma_f32_32x32x16_bf16 v[208:223], a[176:179], v[160:163], v[208:223]
    v_rcp_f32 v133, v133
    v_rcp_f32 v134, v134
    v_rcp_f32_e64 v135, v135
    v_smfmac_f32_16x16x64_bf16 v[56:59], v[36:39], v[20:27], v6
    ds_read2_b64 v[16:19], v3 offset0:74 offset1:206
    ds_read2_b64 v[20:23], v3 offset0:14 offset1:146
    v_mfma_f32_32x32x16_bf16 v[176:191], a[180:183], v[164:167], v[176:191]
    buffer_store_dwordx4 v[68:71], v11, s[8:11], 0 offen sc1 nt
    v_rcp_f32 v136, v136
    v_rcp_f32 v137, v137
    v_rcp_f32_e64 v138, v138
    v_smfmac_f32_16x16x64_bf16 v[60:63], v[36:39], v[24:31], v6
    ds_read2_b32 v[36:37], v4 offset0:164 offset1:165
    ds_read2_b32 v[38:39], v4 offset0:172 offset1:173
    v_mfma_f32_32x32x16_bf16 v[192:207], a[184:187], v[164:167], v[192:207]
    ds_read2_b64 v[24:27], v3 offset0:86 offset1:218
    v_rcp_f32 v139, v139
    v_rcp_f32 v140, v140
    v_rcp_f32_e64 v141, v141
    v_mfma_f32_32x32x16_bf16 v[208:223], a[188:191], v[164:167], v[208:223]
    ds_read2_b64 v[28:31], v3 offset0:26 offset1:158
    ds_write_b128 v0, v[76:79] offset:96
    v_rcp_f32 v142, v142
    v_rcp_f32 v143, v143
    v_pk_mul_f32 v[128:129], v[128:129], v[112:113]
    v_pk_mul_f32 v[130:131], v[130:131], v[114:115]
    v_pk_mul_f32 v[132:133], v[132:133], v[116:117]
    v_pk_mul_f32 v[134:135], v[134:135], v[118:119]
    v_pk_mul_f32 v[136:137], v[136:137], v[120:121]
    v_pk_mul_f32 v[138:139], v[138:139], v[122:123]
    v_pk_mul_f32 v[140:141], v[140:141], v[124:125]
    v_pk_mul_f32 v[142:143], v[142:143], v[126:127]
    v_pk_fma_f32 v[160:161], v[144:145], v[144:145], s[32:33]
    v_pk_fma_f32 v[162:163], v[146:147], v[146:147], s[32:33]
    v_pk_fma_f32 v[164:165], v[148:149], v[148:149], s[32:33]
    v_pk_fma_f32 v[166:167], v[150:151], v[150:151], s[32:33]
    v_pk_fma_f32 v[168:169], v[152:153], v[152:153], s[32:33]
    v_pk_fma_f32 v[170:171], v[154:155], v[154:155], s[32:33]
    v_pk_fma_f32 v[172:173], v[156:157], v[156:157], s[32:33]
    v_pk_fma_f32 v[174:175], v[158:159], v[158:159], s[32:33]
    v_pk_mul_f32 v[160:161], v[160:161], v[144:145] neg_lo:[1,0] neg_hi:[1,0]
    v_pk_mul_f32 v[162:163], v[162:163], v[146:147] neg_lo:[1,0] neg_hi:[1,0]
    v_pk_mul_f32 v[164:165], v[164:165], v[148:149] neg_lo:[1,0] neg_hi:[1,0]
    v_pk_mul_f32 v[166:167], v[166:167], v[150:151] neg_lo:[1,0] neg_hi:[1,0]
    v_pk_mul_f32 v[168:169], v[168:169], v[152:153] neg_lo:[1,0] neg_hi:[1,0]
    v_pk_mul_f32 v[170:171], v[170:171], v[154:155] neg_lo:[1,0] neg_hi:[1,0]
    v_pk_mul_f32 v[172:173], v[172:173], v[156:157] neg_lo:[1,0] neg_hi:[1,0]
    v_pk_mul_f32 v[174:175], v[174:175], v[158:159] neg_lo:[1,0] neg_hi:[1,0]
    v_mfma_f32_32x32x16_bf16 v[112:127], a[96:99], v[88:91], 0
    s_waitcnt lgkmcnt(0)
    v_exp_f32 v160, v160
    v_exp_f32 v161, v161
    v_exp_f32 v162, v162
    v_smfmac_f32_16x16x64_bf16 v[56:59], v[32:35], v[12:19], v6
    ds_read2_b64 v[12:15], v2 offset0:3 offset1:135
    ds_read_b128 v[68:71], v10 offset:59360
    v_mfma_f32_32x32x16_bf16 v[112:127], a[100:103], v[92:95], v[112:127]
    ds_read_b128 v[72:75], v9 offset:64
    ds_read_b128 v[76:79], v9 offset:3392
    v_exp_f32 v163, v163
    v_exp_f32 v164, v164
    v_smfmac_f32_16x16x64_bf16 v[60:63], v[32:35], v[16:23], v6
    ds_read2_b32 v[32:33], v5 offset0:0 offset1:1
    ds_read2_b32 v[34:35], v5 offset0:8 offset1:9
    v_mfma_f32_32x32x16_bf16 v[112:127], a[104:107], v[96:99], v[112:127]
    ds_read_b128 v[64:67], v10 offset:59360
    v_cvt_pk_bf16_f32 v128, v128, v129
    v_exp_f32 v165, v165
    v_exp_f32 v166, v166
    v_smfmac_f32_16x16x64_bf16 v[56:59], v[36:39], v[20:27], v6
    ds_read2_b64 v[16:19], v2 offset0:75 offset1:207
    ds_read2_b64 v[20:23], v2 offset0:15 offset1:147
    v_mfma_f32_32x32x16_bf16 v[112:127], a[108:111], v[100:103], v[112:127]
    v_exp_f32 v167, v167
    v_exp_f32 v168, v168
    v_exp_f32_e64 v169, v169
    v_smfmac_f32_16x16x64_bf16 v[60:63], v[36:39], v[24:31], v6
    ds_read2_b32 v[36:37], v5 offset0:4 offset1:5
    ds_read2_b32 v[38:39], v5 offset0:12 offset1:13
    v_mfma_f32_32x32x16_bf16 v[112:127], a[112:115], v[104:107], v[112:127]
    ds_read2_b64 v[24:27], v2 offset0:87 offset1:219
    v_cvt_pk_bf16_f32 v129, v130, v131
    v_exp_f32 v170, v170
    v_exp_f32 v171, v171
    v_mfma_f32_32x32x16_bf16 v[112:127], a[116:119], v[108:111], v[112:127]
    ds_read2_b64 v[28:31], v2 offset0:27 offset1:159
    ds_write_b128 v0, v[80:83] offset:128
    v_cvt_pk_bf16_f32 v130, v132, v133
    v_cvt_pk_bf16_f32 v131, v134, v135
    v_exp_f32 v172, v172
    v_exp_f32 v173, v173
    v_exp_f32 v174, v174
    v_exp_f32_e64 v175, v175
    v_pk_fma_f32 v[160:161], v[160:161], s[34:35], s[34:35]
    v_pk_fma_f32 v[162:163], v[162:163], s[34:35], s[34:35]
    v_pk_fma_f32 v[164:165], v[164:165], s[34:35], s[34:35]
    v_pk_fma_f32 v[166:167], v[166:167], s[34:35], s[34:35]
    v_pk_fma_f32 v[168:169], v[168:169], s[34:35], s[34:35]
    v_pk_fma_f32 v[170:171], v[170:171], s[34:35], s[34:35]
    v_pk_fma_f32 v[172:173], v[172:173], s[34:35], s[34:35]
    v_pk_fma_f32 v[174:175], v[174:175], s[34:35], s[34:35]
    v_mfma_f32_32x32x16_bf16 v[176:191], a[192:195], v[128:131], v[176:191]
    s_waitcnt lgkmcnt(0)
    v_cvt_pk_bf16_f32 v132, v136, v137
    v_cvt_pk_bf16_f32 v133, v138, v139
    v_cvt_pk_bf16_f32 v134, v140, v141
    v_cvt_pk_bf16_f32 v135, v142, v143
    v_rcp_f32 v160, v160
    v_smfmac_f32_16x16x64_bf16 v[64:67], v[32:35], v[12:19], v6
    ds_read2_b64 v[12:15], v3 offset0:3 offset1:135
    v_rcp_f32 v161, v161
    v_mfma_f32_32x32x16_bf16 v[192:207], a[196:199], v[128:131], v[192:207]
    buffer_store_dwordx4 v[72:75], v11, s[24:27], 0 offen offset:64 sc1 nt
    v_rcp_f32 v162, v162
    v_rcp_f32 v163, v163
    v_rcp_f32_e64 v164, v164
    v_smfmac_f32_16x16x64_bf16 v[68:71], v[32:35], v[16:23], v6
    ds_read2_b32 v[32:33], v5 offset0:32 offset1:33
    ds_read2_b32 v[34:35], v5 offset0:40 offset1:41
    v_mfma_f32_32x32x16_bf16 v[208:223], a[200:203], v[128:131], v[208:223]
    s_mov_b32 m0, 0x15cb0
    v_rcp_f32 v165, v165
    v_rcp_f32 v166, v166
    v_rcp_f32_e64 v167, v167
    v_smfmac_f32_16x16x64_bf16 v[64:67], v[36:39], v[20:27], v6
    ds_read2_b64 v[16:19], v3 offset0:75 offset1:207
    ds_read2_b64 v[20:23], v3 offset0:15 offset1:147
    v_mfma_f32_32x32x16_bf16 v[176:191], a[204:207], v[132:135], v[176:191]
    buffer_store_dwordx4 v[76:79], v11, s[8:11], 0 offen offset:64 sc1 nt
    v_rcp_f32 v168, v168
    v_rcp_f32 v169, v169
    v_rcp_f32_e64 v170, v170
    v_smfmac_f32_16x16x64_bf16 v[68:71], v[36:39], v[24:31], v6
    ds_read2_b32 v[36:37], v5 offset0:36 offset1:37
    ds_read2_b32 v[38:39], v5 offset0:44 offset1:45
    v_mfma_f32_32x32x16_bf16 v[192:207], a[208:211], v[132:135], v[192:207]
    ds_read2_b64 v[24:27], v3 offset0:87 offset1:219
    v_rcp_f32 v171, v171
    v_rcp_f32 v172, v172
    v_rcp_f32_e64 v173, v173
    v_mfma_f32_32x32x16_bf16 v[208:223], a[212:215], v[132:135], v[208:223]
    ds_read2_b64 v[28:31], v3 offset0:27 offset1:159
    ds_write_b128 v0, v[84:87] offset:160
    v_rcp_f32 v174, v174
    v_rcp_f32 v175, v175
    v_add_u32_e64 v0, s47, v1
    v_pk_mul_f32 v[160:161], v[160:161], v[144:145]
    v_pk_mul_f32 v[162:163], v[162:163], v[146:147]
    v_pk_mul_f32 v[164:165], v[164:165], v[148:149]
    v_pk_mul_f32 v[166:167], v[166:167], v[150:151]
    v_pk_mul_f32 v[168:169], v[168:169], v[152:153]
    v_pk_mul_f32 v[170:171], v[170:171], v[154:155]
    v_pk_mul_f32 v[172:173], v[172:173], v[156:157]
    v_pk_mul_f32 v[174:175], v[174:175], v[158:159]
    v_pk_fma_f32 v[128:129], v[112:113], v[112:113], s[32:33]
    v_pk_fma_f32 v[130:131], v[114:115], v[114:115], s[32:33]
    v_pk_fma_f32 v[132:133], v[116:117], v[116:117], s[32:33]
    v_pk_fma_f32 v[134:135], v[118:119], v[118:119], s[32:33]
    v_pk_fma_f32 v[136:137], v[120:121], v[120:121], s[32:33]
    v_pk_fma_f32 v[138:139], v[122:123], v[122:123], s[32:33]
    v_pk_fma_f32 v[140:141], v[124:125], v[124:125], s[32:33]
    v_pk_fma_f32 v[142:143], v[126:127], v[126:127], s[32:33]
    v_pk_mul_f32 v[128:129], v[128:129], v[112:113] neg_lo:[1,0] neg_hi:[1,0]
    v_pk_mul_f32 v[130:131], v[130:131], v[114:115] neg_lo:[1,0] neg_hi:[1,0]
    v_pk_mul_f32 v[132:133], v[132:133], v[116:117] neg_lo:[1,0] neg_hi:[1,0]
    v_pk_mul_f32 v[134:135], v[134:135], v[118:119] neg_lo:[1,0] neg_hi:[1,0]
    v_pk_mul_f32 v[136:137], v[136:137], v[120:121] neg_lo:[1,0] neg_hi:[1,0]
    v_pk_mul_f32 v[138:139], v[138:139], v[122:123] neg_lo:[1,0] neg_hi:[1,0]
    v_pk_mul_f32 v[140:141], v[140:141], v[124:125] neg_lo:[1,0] neg_hi:[1,0]
    v_pk_mul_f32 v[142:143], v[142:143], v[126:127] neg_lo:[1,0] neg_hi:[1,0]
    v_mfma_f32_32x32x16_bf16 v[144:159], a[120:123], v[88:91], 0
    s_waitcnt lgkmcnt(0)
    ds_read_b128 v[80:83], v9 offset:128
    ds_read_b128 v[84:87], v9 offset:3456
    v_and_b32 v9, 16, v8
    v_mad_u32_u24 v9, v9, 7, v8
    v_cvt_pk_bf16_f32 v160, v160, v161
    v_smfmac_f32_16x16x64_bf16 v[64:67], v[32:35], v[12:19], v6
    ds_read2_b64 v[12:15], v2 offset0:4 offset1:136
    ds_read_b128 v[76:79], v10 offset:59360
    v_mfma_f32_32x32x16_bf16 v[144:159], a[124:127], v[92:95], v[144:159]
    ds_read_b128 v[88:91], v0
    v_cvt_pk_bf16_f32 v161, v162, v163
    v_exp_f32 v128, v128
    v_exp_f32 v129, v129
    v_smfmac_f32_16x16x64_bf16 v[68:71], v[32:35], v[16:23], v6
    ds_read2_b32 v[32:33], v5 offset0:64 offset1:65
    ds_read2_b32 v[34:35], v5 offset0:72 offset1:73
    v_mfma_f32_32x32x16_bf16 v[144:159], a[128:131], v[96:99], v[144:159]
    ds_read_b128 v[92:95], v0 offset:1024
    v_cvt_pk_bf16_f32 v162, v164, v165
    v_exp_f32 v130, v130
    v_exp_f32 v131, v131
    v_smfmac_f32_16x16x64_bf16 v[64:67], v[36:39], v[20:27], v6
    ds_read2_b64 v[16:19], v2 offset0:76 offset1:208
    ds_read2_b64 v[20:23], v2 offset0:16 offset1:148
    v_mfma_f32_32x32x16_bf16 v[144:159], a[132:135], v[100:103], v[144:159]
    ds_read_b128 v[96:99], v0 offset:2048
    v_cvt_pk_bf16_f32 v163, v166, v167
    v_exp_f32 v132, v132
    v_exp_f32 v133, v133
    v_smfmac_f32_16x16x64_bf16 v[68:71], v[36:39], v[24:31], v6
    ds_read2_b32 v[36:37], v5 offset0:68 offset1:69
    ds_read2_b32 v[38:39], v5 offset0:76 offset1:77
    v_mfma_f32_32x32x16_bf16 v[144:159], a[136:139], v[104:107], v[144:159]
    ds_read2_b64 v[24:27], v2 offset0:88 offset1:220
    buffer_load_dword v9, s[4:7], s43 offen lds
    v_exp_f32 v134, v134
    v_exp_f32 v135, v135
    v_mfma_f32_32x32x16_bf16 v[144:159], a[140:143], v[108:111], v[144:159]
    ds_read2_b64 v[28:31], v2 offset0:28 offset1:160
    ds_read_b128 v[72:75], v10 offset:59360
    v_exp_f32 v136, v136
    v_exp_f32 v137, v137
    v_exp_f32 v138, v138
    v_exp_f32 v139, v139
    v_exp_f32 v140, v140
    v_exp_f32 v141, v141
    v_exp_f32 v142, v142
    v_exp_f32_e64 v143, v143
    v_pk_fma_f32 v[128:129], v[128:129], s[34:35], s[34:35]
    v_pk_fma_f32 v[130:131], v[130:131], s[34:35], s[34:35]
    v_pk_fma_f32 v[132:133], v[132:133], s[34:35], s[34:35]
    v_pk_fma_f32 v[134:135], v[134:135], s[34:35], s[34:35]
    v_pk_fma_f32 v[136:137], v[136:137], s[34:35], s[34:35]
    v_pk_fma_f32 v[138:139], v[138:139], s[34:35], s[34:35]
    v_pk_fma_f32 v[140:141], v[140:141], s[34:35], s[34:35]
    v_pk_fma_f32 v[142:143], v[142:143], s[34:35], s[34:35]
    v_mfma_f32_32x32x16_bf16 v[176:191], a[216:219], v[160:163], v[176:191]
    s_waitcnt lgkmcnt(0)
    v_cvt_pk_bf16_f32 v164, v168, v169
    v_cvt_pk_bf16_f32 v165, v170, v171
    v_cvt_pk_bf16_f32 v166, v172, v173
    v_cvt_pk_bf16_f32 v167, v174, v175
    v_rcp_f32_e64 v128, v128
    v_smfmac_f32_16x16x64_bf16 v[72:75], v[32:35], v[12:19], v6
    ds_read2_b64 v[12:15], v3 offset0:4 offset1:136
    buffer_store_dwordx4 v[80:83], v11, s[24:27], 0 offen offset:128 sc1 nt
    v_mfma_f32_32x32x16_bf16 v[192:207], a[220:223], v[160:163], v[192:207]
    ds_read_b128 v[100:103], v0 offset:3072
    v_rcp_f32 v129, v129
    v_rcp_f32 v130, v130
    v_rcp_f32_e64 v131, v131
    v_smfmac_f32_16x16x64_bf16 v[76:79], v[32:35], v[16:23], v6
    ds_read2_b32 v[32:33], v5 offset0:96 offset1:97
    ds_read2_b32 v[34:35], v5 offset0:104 offset1:105
    v_mfma_f32_32x32x16_bf16 v[208:223], a[224:227], v[160:163], v[208:223]
    ds_read_b128 v[104:107], v0 offset:4096
    v_rcp_f32 v132, v132
    v_rcp_f32 v133, v133
    v_rcp_f32_e64 v134, v134
    v_smfmac_f32_16x16x64_bf16 v[72:75], v[36:39], v[20:27], v6
    ds_read2_b64 v[16:19], v3 offset0:76 offset1:208
    ds_read2_b64 v[20:23], v3 offset0:16 offset1:148
    v_mfma_f32_32x32x16_bf16 v[176:191], a[228:231], v[164:167], v[176:191]
    ds_read_b128 v[108:111], v0 offset:5120
    v_rcp_f32 v135, v135
    v_rcp_f32 v136, v136
    v_rcp_f32_e64 v137, v137
    v_smfmac_f32_16x16x64_bf16 v[76:79], v[36:39], v[24:31], v6
    ds_read2_b32 v[36:37], v5 offset0:100 offset1:101
    ds_read2_b32 v[38:39], v5 offset0:108 offset1:109
    v_mfma_f32_32x32x16_bf16 v[192:207], a[232:235], v[164:167], v[192:207]
    ds_read2_b64 v[24:27], v3 offset0:88 offset1:220
    v_rcp_f32 v138, v138
    v_rcp_f32 v139, v139
    v_mfma_f32_32x32x16_bf16 v[208:223], a[236:239], v[164:167], v[208:223]
    ds_read2_b64 v[28:31], v3 offset0:28 offset1:160
    buffer_store_dwordx4 v[84:87], v11, s[8:11], 0 offen offset:128 sc1 nt
    v_rcp_f32 v140, v140
    v_rcp_f32 v141, v141
    v_rcp_f32 v142, v142
    v_rcp_f32 v143, v143
    v_pk_mul_f32 v[128:129], v[128:129], v[112:113]
    v_pk_mul_f32 v[130:131], v[130:131], v[114:115]
    v_pk_mul_f32 v[132:133], v[132:133], v[116:117]
    v_pk_mul_f32 v[134:135], v[134:135], v[118:119]
    v_pk_mul_f32 v[136:137], v[136:137], v[120:121]
    v_pk_mul_f32 v[138:139], v[138:139], v[122:123]
    v_pk_mul_f32 v[140:141], v[140:141], v[124:125]
    v_pk_mul_f32 v[142:143], v[142:143], v[126:127]
    v_pk_fma_f32 v[160:161], v[144:145], v[144:145], s[32:33]
    v_pk_fma_f32 v[162:163], v[146:147], v[146:147], s[32:33]
    v_pk_fma_f32 v[164:165], v[148:149], v[148:149], s[32:33]
    v_pk_fma_f32 v[166:167], v[150:151], v[150:151], s[32:33]
    v_pk_fma_f32 v[168:169], v[152:153], v[152:153], s[32:33]
    v_pk_fma_f32 v[170:171], v[154:155], v[154:155], s[32:33]
    v_pk_fma_f32 v[172:173], v[156:157], v[156:157], s[32:33]
    v_pk_fma_f32 v[174:175], v[158:159], v[158:159], s[32:33]
    v_pk_mul_f32 v[160:161], v[160:161], v[144:145] neg_lo:[1,0] neg_hi:[1,0]
    v_pk_mul_f32 v[162:163], v[162:163], v[146:147] neg_lo:[1,0] neg_hi:[1,0]
    v_pk_mul_f32 v[164:165], v[164:165], v[148:149] neg_lo:[1,0] neg_hi:[1,0]
    v_pk_mul_f32 v[166:167], v[166:167], v[150:151] neg_lo:[1,0] neg_hi:[1,0]
    v_pk_mul_f32 v[168:169], v[168:169], v[152:153] neg_lo:[1,0] neg_hi:[1,0]
    v_pk_mul_f32 v[170:171], v[170:171], v[154:155] neg_lo:[1,0] neg_hi:[1,0]
    v_pk_mul_f32 v[172:173], v[172:173], v[156:157] neg_lo:[1,0] neg_hi:[1,0]
    v_pk_mul_f32 v[174:175], v[174:175], v[158:159] neg_lo:[1,0] neg_hi:[1,0]
    s_waitcnt lgkmcnt(0)
    v_mfma_f32_32x32x16_bf16 v[112:127], a[0:3], v[88:91], 0
    s_add_u32 s24, s24, s55
    v_exp_f32 v160, v160
    v_exp_f32 v161, v161
    v_exp_f32_e64 v162, v162
    v_smfmac_f32_16x16x64_bf16 v[72:75], v[32:35], v[12:19], v6
    ds_read2_b64 v[12:15], v2 offset0:5 offset1:137
    ds_read_b128 v[84:87], v10 offset:59360
    v_mfma_f32_32x32x16_bf16 v[112:127], a[4:7], v[92:95], v[112:127]
    s_addc_u32 s25, s25, s3
    v_exp_f32 v163, v163
    v_exp_f32 v164, v164
    v_exp_f32 v165, v165
    v_smfmac_f32_16x16x64_bf16 v[76:79], v[32:35], v[16:23], v6
    ds_read2_b32 v[32:33], v5 offset0:128 offset1:129
    ds_read2_b32 v[34:35], v5 offset0:136 offset1:137
    v_mfma_f32_32x32x16_bf16 v[112:127], a[8:11], v[96:99], v[112:127]
    s_add_u32 s8, s8, s55
    v_exp_f32 v166, v166
    v_exp_f32 v167, v167
    v_exp_f32 v168, v168
    v_smfmac_f32_16x16x64_bf16 v[72:75], v[36:39], v[20:27], v6
    ds_read2_b64 v[16:19], v2 offset0:77 offset1:209
    ds_read2_b64 v[20:23], v2 offset0:17 offset1:149
    v_mfma_f32_32x32x16_bf16 v[112:127], a[12:15], v[100:103], v[112:127]
    s_addc_u32 s9, s9, s3
    v_exp_f32 v169, v169
    v_exp_f32 v170, v170
    v_exp_f32 v171, v171
    v_smfmac_f32_16x16x64_bf16 v[76:79], v[36:39], v[24:31], v6
    ds_read2_b32 v[36:37], v5 offset0:132 offset1:133
    ds_read2_b32 v[38:39], v5 offset0:140 offset1:141
    v_mfma_f32_32x32x16_bf16 v[112:127], a[16:19], v[104:107], v[112:127]
    ds_read2_b64 v[24:27], v2 offset0:89 offset1:221
    v_cvt_pk_bf16_f32 v128, v128, v129
    v_exp_f32 v172, v172
    v_exp_f32 v173, v173
    v_mfma_f32_32x32x16_bf16 v[112:127], a[20:23], v[108:111], v[112:127]
    ds_read2_b64 v[28:31], v2 offset0:29 offset1:161
    ds_read_b128 v[80:83], v10 offset:59360
    v_cvt_pk_bf16_f32 v129, v130, v131
    v_cvt_pk_bf16_f32 v130, v132, v133
    v_cvt_pk_bf16_f32 v131, v134, v135
    v_exp_f32 v174, v174
    v_exp_f32 v175, v175
    v_add_u32_e64 v9, s48, v1
    v_pk_fma_f32 v[160:161], v[160:161], s[34:35], s[34:35]
    v_pk_fma_f32 v[162:163], v[162:163], s[34:35], s[34:35]
    v_pk_fma_f32 v[164:165], v[164:165], s[34:35], s[34:35]
    v_pk_fma_f32 v[166:167], v[166:167], s[34:35], s[34:35]
    v_pk_fma_f32 v[168:169], v[168:169], s[34:35], s[34:35]
    v_pk_fma_f32 v[170:171], v[170:171], s[34:35], s[34:35]
    v_pk_fma_f32 v[172:173], v[172:173], s[34:35], s[34:35]
    v_pk_fma_f32 v[174:175], v[174:175], s[34:35], s[34:35]
    v_mfma_f32_32x32x16_bf16 v[176:191], a[240:243], v[128:131], v[176:191]
    s_waitcnt lgkmcnt(0)
    v_cvt_pk_bf16_f32 v132, v136, v137
    v_cvt_pk_bf16_f32 v133, v138, v139
    v_cvt_pk_bf16_f32 v134, v140, v141
    v_cvt_pk_bf16_f32 v135, v142, v143
    v_rcp_f32 v160, v160
    v_smfmac_f32_16x16x64_bf16 v[80:83], v[32:35], v[12:19], v6
    ds_read2_b64 v[12:15], v3 offset0:5 offset1:137
    v_rcp_f32 v161, v161
    v_mfma_f32_32x32x16_bf16 v[192:207], a[244:247], v[128:131], v[192:207]
    s_cmp_lt_u32 s45, s44
    v_rcp_f32 v162, v162
    v_rcp_f32 v163, v163
    v_rcp_f32_e64 v164, v164
    v_smfmac_f32_16x16x64_bf16 v[84:87], v[32:35], v[16:23], v6
    ds_read2_b32 v[32:33], v5 offset0:160 offset1:161
    ds_read2_b32 v[34:35], v5 offset0:168 offset1:169
    v_mfma_f32_32x32x16_bf16 v[208:223], a[248:251], v[128:131], v[208:223]
    s_cselect_b32 s18, 0x18c80, 0
    v_rcp_f32 v165, v165
    v_rcp_f32 v166, v166
    v_rcp_f32_e64 v167, v167
    v_smfmac_f32_16x16x64_bf16 v[80:83], v[36:39], v[20:27], v6
    ds_read2_b64 v[16:19], v3 offset0:77 offset1:209
    ds_read2_b64 v[20:23], v3 offset0:17 offset1:149
    v_mfma_f32_32x32x16_bf16 v[176:191], a[252:255], v[132:135], v[176:191]
    s_mov_b32 s10, 0xc00
    v_rcp_f32 v168, v168
    v_rcp_f32 v169, v169
    v_rcp_f32_e64 v170, v170
    v_smfmac_f32_16x16x64_bf16 v[84:87], v[36:39], v[24:31], v6
    ds_read2_b32 v[36:37], v5 offset0:164 offset1:165
    ds_read2_b32 v[38:39], v5 offset0:172 offset1:173
    v_mfma_f32_32x32x16_bf16 v[192:207], v[224:227], v[132:135], v[192:207]
    ds_read2_b64 v[24:27], v3 offset0:89 offset1:221
    v_rcp_f32 v171, v171
    v_rcp_f32 v172, v172
    v_mfma_f32_32x32x16_bf16 v[208:223], v[228:231], v[132:135], v[208:223]
    ds_read2_b64 v[28:31], v3 offset0:29 offset1:161
    v_rcp_f32 v173, v173
    v_rcp_f32 v174, v174
    v_rcp_f32 v175, v175
    v_mul_f32 v160, v160, v144
    v_mul_f32_e64 v161, v161, v145
    v_pk_mul_f32 v[162:163], v[162:163], v[146:147]
    v_pk_mul_f32 v[164:165], v[164:165], v[148:149]
    v_pk_mul_f32 v[166:167], v[166:167], v[150:151]
    v_pk_mul_f32 v[168:169], v[168:169], v[152:153]
    v_pk_mul_f32 v[170:171], v[170:171], v[154:155]
    v_pk_mul_f32 v[172:173], v[172:173], v[156:157]
    v_pk_mul_f32 v[174:175], v[174:175], v[158:159]
    v_pk_fma_f32 v[128:129], v[112:113], v[112:113], s[32:33]
    v_pk_fma_f32 v[130:131], v[114:115], v[114:115], s[32:33]
    v_pk_fma_f32 v[132:133], v[116:117], v[116:117], s[32:33]
    v_pk_fma_f32 v[134:135], v[118:119], v[118:119], s[32:33]
    v_pk_fma_f32 v[136:137], v[120:121], v[120:121], s[32:33]
    v_pk_fma_f32 v[138:139], v[122:123], v[122:123], s[32:33]
    v_pk_fma_f32 v[140:141], v[124:125], v[124:125], s[32:33]
    v_pk_fma_f32 v[142:143], v[126:127], v[126:127], s[32:33]
    v_pk_mul_f32 v[128:129], v[128:129], v[112:113] neg_lo:[1,0] neg_hi:[1,0]
    v_pk_mul_f32 v[130:131], v[130:131], v[114:115] neg_lo:[1,0] neg_hi:[1,0]
    v_pk_mul_f32 v[132:133], v[132:133], v[116:117] neg_lo:[1,0] neg_hi:[1,0]
    v_pk_mul_f32 v[134:135], v[134:135], v[118:119] neg_lo:[1,0] neg_hi:[1,0]
    v_pk_mul_f32 v[136:137], v[136:137], v[120:121] neg_lo:[1,0] neg_hi:[1,0]
    v_pk_mul_f32 v[138:139], v[138:139], v[122:123] neg_lo:[1,0] neg_hi:[1,0]
    v_pk_mul_f32 v[140:141], v[140:141], v[124:125] neg_lo:[1,0] neg_hi:[1,0]
    v_pk_mul_f32 v[142:143], v[142:143], v[126:127] neg_lo:[1,0] neg_hi:[1,0]
    v_cvt_pk_bf16_f32 v160, v160, v161
    v_add_u32 v11, 0x15830, v1
    s_waitcnt lgkmcnt(0)
    v_smfmac_f32_16x16x64_bf16 v[80:83], v[32:35], v[12:19], v6
    v_cvt_pk_bf16_f32 v161, v162, v163
    v_smfmac_f32_16x16x64_bf16 v[84:87], v[32:35], v[16:23], v6
    v_cvt_pk_bf16_f32 v162, v164, v165
    v_smfmac_f32_16x16x64_bf16 v[80:83], v[36:39], v[20:27], v6
    v_cvt_pk_bf16_f32 v163, v166, v167
    v_smfmac_f32_16x16x64_bf16 v[84:87], v[36:39], v[24:31], v6
    v_cvt_pk_bf16_f32 v164, v168, v169
    v_mfma_f32_32x32x16_bf16 v[176:191], v[232:235], v[160:163], v[176:191]
    v_cvt_pk_bf16_f32 v165, v170, v171
    v_cvt_pk_bf16_f32 v166, v172, v173
    v_cvt_pk_bf16_f32 v167, v174, v175
    v_add_u32 v10, s49, v1
    v_exp_f32_e64 v128, v128
    v_mfma_f32_32x32x16_bf16 v[176:191], v[244:247], v[164:167], v[176:191]
    ds_read_b128 v[32:35], v11
    ds_read_b32 v36, v11 offset:140
    v_exp_f32 v129, v129
    v_exp_f32 v130, v130
    v_mfma_f32_32x32x16_bf16 v[192:207], v[236:239], v[160:163], v[192:207]
    v_exp_f32 v131, v131
    v_exp_f32 v132, v132
    v_exp_f32 v133, v133
    v_mfma_f32_32x32x16_bf16 v[192:207], v[248:251], v[164:167], v[192:207]
    ds_write_b128 v9, v[176:179]
    v_add_u32 v0, s50, v1
    v_mfma_f32_32x32x16_bf16 v[208:223], v[240:243], v[160:163], v[208:223]
    v_exp_f32 v134, v134
    v_exp_f32 v135, v135
    v_exp_f32 v136, v136
    v_mfma_f32_32x32x16_bf16 v[208:223], v[252:255], v[164:167], v[208:223]
    ds_write_b128 v9, v[180:183] offset:1024
    v_exp_f32 v137, v137
    v_exp_f32 v138, v138
    v_exp_f32 v139, v139
    v_exp_f32 v140, v140
    ds_write_b128 v9, v[184:187] offset:2048
    v_exp_f32 v141, v141
    v_exp_f32 v142, v142
    v_exp_f32 v143, v143
    v_pk_fma_f32 v[128:129], v[128:129], s[34:35], s[34:35]
    v_pk_fma_f32 v[130:131], v[130:131], s[34:35], s[34:35]
    v_pk_fma_f32 v[132:133], v[132:133], s[34:35], s[34:35]
    v_pk_fma_f32 v[134:135], v[134:135], s[34:35], s[34:35]
    v_pk_fma_f32 v[136:137], v[136:137], s[34:35], s[34:35]
    v_pk_fma_f32 v[138:139], v[138:139], s[34:35], s[34:35]
    v_pk_fma_f32 v[140:141], v[140:141], s[34:35], s[34:35]
    ds_write_b128 v9, v[188:191] offset:3072
    v_pk_fma_f32 v[142:143], v[142:143], s[34:35], s[34:35]
    v_pk_add_f32 v[12:13], v[40:41], v[42:43]
    v_pk_mul_f32 v[16:17], v[40:41], v[40:41]
    v_pk_fma_f32 v[16:17], v[42:43], v[42:43], v[16:17]
    v_pk_add_f32 v[14:15], v[44:45], v[46:47]
    v_pk_mul_f32 v[18:19], v[44:45], v[44:45]
    v_pk_fma_f32 v[18:19], v[46:47], v[46:47], v[18:19]
    v_pk_add_f32 v[12:13], v[12:13], v[48:49]
    v_pk_fma_f32 v[16:17], v[48:49], v[48:49], v[16:17]
    v_pk_add_f32 v[12:13], v[12:13], v[50:51]
    v_pk_fma_f32 v[16:17], v[50:51], v[50:51], v[16:17]
    v_pk_add_f32 v[14:15], v[14:15], v[52:53]
    v_pk_fma_f32 v[18:19], v[52:53], v[52:53], v[18:19]
    v_pk_add_f32 v[14:15], v[14:15], v[54:55]
    v_pk_fma_f32 v[18:19], v[54:55], v[54:55], v[18:19]
    ds_write_b128 v9, v[192:195] offset:4096
    v_pk_add_f32 v[12:13], v[12:13], v[56:57]
    v_pk_fma_f32 v[16:17], v[56:57], v[56:57], v[16:17]
    v_pk_add_f32 v[12:13], v[12:13], v[58:59]
    v_pk_fma_f32 v[16:17], v[58:59], v[58:59], v[16:17]
    v_pk_add_f32 v[14:15], v[14:15], v[60:61]
    v_pk_fma_f32 v[18:19], v[60:61], v[60:61], v[18:19]
    v_pk_add_f32 v[14:15], v[14:15], v[62:63]
    v_pk_fma_f32 v[18:19], v[62:63], v[62:63], v[18:19]
    v_mfma_f32_32x32x16_bf16 v[144:159], a[24:27], v[88:91], 0
    ds_write_b128 v9, v[196:199] offset:5120
    v_rcp_f32 v128, v128
    v_mfma_f32_32x32x16_bf16 v[144:159], a[28:31], v[92:95], v[144:159]
    v_rcp_f32 v129, v129
    v_rcp_f32 v130, v130
    v_rcp_f32 v131, v131
    v_mfma_f32_32x32x16_bf16 v[144:159], a[32:35], v[96:99], v[144:159]
    ds_write_b128 v9, v[200:203] offset:6144
    v_rcp_f32 v132, v132
    v_mfma_f32_32x32x16_bf16 v[144:159], a[36:39], v[100:103], v[144:159]
    v_rcp_f32 v133, v133
    v_rcp_f32 v134, v134
    v_rcp_f32 v135, v135
    v_mfma_f32_32x32x16_bf16 v[144:159], a[40:43], v[104:107], v[144:159]
    ds_write_b128 v9, v[204:207] offset:7168
    v_rcp_f32 v136, v136
    v_mfma_f32_32x32x16_bf16 v[144:159], a[44:47], v[108:111], v[144:159]
    s_mov_b32 s26, 0xc00
    v_rcp_f32 v137, v137
    v_rcp_f32 v138, v138
    v_rcp_f32 v139, v139
    v_rcp_f32 v140, v140
    ds_write_b128 v9, v[208:211] offset:8192
    v_rcp_f32 v141, v141
    v_rcp_f32 v142, v142
    v_rcp_f32 v143, v143
    v_pk_add_f32 v[12:13], v[12:13], v[64:65]
    v_pk_fma_f32 v[16:17], v[64:65], v[64:65], v[16:17]
    ds_write_b128 v9, v[212:215] offset:9216
    v_pk_add_f32 v[12:13], v[12:13], v[66:67]
    v_pk_fma_f32 v[16:17], v[66:67], v[66:67], v[16:17]
    v_pk_add_f32 v[14:15], v[14:15], v[68:69]
    v_pk_fma_f32 v[18:19], v[68:69], v[68:69], v[18:19]
    v_pk_add_f32 v[14:15], v[14:15], v[70:71]
    v_pk_fma_f32 v[18:19], v[70:71], v[70:71], v[18:19]
    v_pk_add_f32 v[12:13], v[12:13], v[72:73]
    v_pk_fma_f32 v[16:17], v[72:73], v[72:73], v[16:17]
    v_pk_add_f32 v[12:13], v[12:13], v[74:75]
    v_pk_fma_f32 v[16:17], v[74:75], v[74:75], v[16:17]
    v_pk_add_f32 v[14:15], v[14:15], v[76:77]
    v_pk_fma_f32 v[18:19], v[76:77], v[76:77], v[18:19]
    v_pk_add_f32 v[14:15], v[14:15], v[78:79]
    ds_write_b128 v9, v[216:219] offset:10240
    v_pk_fma_f32 v[18:19], v[78:79], v[78:79], v[18:19]
    v_pk_add_f32 v[12:13], v[12:13], v[80:81]
    v_pk_fma_f32 v[16:17], v[80:81], v[80:81], v[16:17]
    v_pk_add_f32 v[12:13], v[12:13], v[82:83]
    v_pk_fma_f32 v[16:17], v[82:83], v[82:83], v[16:17]
    v_pk_add_f32 v[14:15], v[14:15], v[84:85]
    v_pk_fma_f32 v[18:19], v[84:85], v[84:85], v[18:19]
    v_pk_add_f32 v[14:15], v[14:15], v[86:87]
    v_pk_fma_f32 v[18:19], v[86:87], v[86:87], v[18:19]
    v_add_f32 v12, v12, v13
    v_add_f32 v13, v14, v15
    v_add_f32 v14, v16, v17
    v_add_f32 v15, v18, v19
    ds_write_b128 v0, v[12:15]
    v_pk_mul_f32 v[128:129], v[128:129], v[112:113]
    v_pk_mul_f32 v[130:131], v[130:131], v[114:115]
    v_pk_mul_f32 v[132:133], v[132:133], v[116:117]
    v_pk_mul_f32 v[134:135], v[134:135], v[118:119]
    v_pk_mul_f32 v[136:137], v[136:137], v[120:121]
    v_pk_mul_f32 v[138:139], v[138:139], v[122:123]
    v_pk_mul_f32 v[140:141], v[140:141], v[124:125]
    v_pk_mul_f32 v[142:143], v[142:143], v[126:127]
    v_pk_fma_f32 v[160:161], v[144:145], v[144:145], s[32:33]
    v_pk_fma_f32 v[162:163], v[146:147], v[146:147], s[32:33]
    v_pk_fma_f32 v[164:165], v[148:149], v[148:149], s[32:33]
    v_pk_fma_f32 v[166:167], v[150:151], v[150:151], s[32:33]
    v_pk_fma_f32 v[168:169], v[152:153], v[152:153], s[32:33]
    ds_write_b128 v9, v[220:223] offset:11264
    v_pk_fma_f32 v[170:171], v[154:155], v[154:155], s[32:33]
    v_pk_fma_f32 v[172:173], v[156:157], v[156:157], s[32:33]
    v_pk_fma_f32 v[174:175], v[158:159], v[158:159], s[32:33]
    v_pk_mul_f32 v[160:161], v[160:161], v[144:145] neg_lo:[1,0] neg_hi:[1,0]
    v_pk_mul_f32 v[162:163], v[162:163], v[146:147] neg_lo:[1,0] neg_hi:[1,0]
    v_pk_mul_f32 v[164:165], v[164:165], v[148:149] neg_lo:[1,0] neg_hi:[1,0]
    v_pk_mul_f32 v[166:167], v[166:167], v[150:151] neg_lo:[1,0] neg_hi:[1,0]
    v_pk_mul_f32 v[168:169], v[168:169], v[152:153] neg_lo:[1,0] neg_hi:[1,0]
    v_pk_mul_f32 v[170:171], v[170:171], v[154:155] neg_lo:[1,0] neg_hi:[1,0]
    v_pk_mul_f32 v[172:173], v[172:173], v[156:157] neg_lo:[1,0] neg_hi:[1,0]
    v_pk_mul_f32 v[174:175], v[174:175], v[158:159] neg_lo:[1,0] neg_hi:[1,0]
    v_mfma_f32_32x32x16_bf16 v[112:127], a[48:51], v[88:91], 0
    v_exp_f32 v160, v160
    v_exp_f32 v161, v161
    v_exp_f32_e64 v162, v162
    v_mfma_f32_32x32x16_bf16 v[112:127], a[52:55], v[92:95], v[112:127]
    s_waitcnt lgkmcnt(0)
    s_barrier
    ds_read_b128 v[176:179], v10
    ds_read_b128 v[180:183], v10 offset:1024
    v_mfma_f32_32x32x16_bf16 v[112:127], a[56:59], v[96:99], v[112:127]
    ds_read_b128 v[184:187], v10 offset:2048
    ds_read_b128 v[188:191], v10 offset:3072
    v_exp_f32 v163, v163
    v_exp_f32 v164, v164
    v_mfma_f32_32x32x16_bf16 v[112:127], a[60:63], v[100:103], v[112:127]
    ds_read_b128 v[192:195], v10 offset:4096
    ds_read_b128 v[196:199], v10 offset:5120
    v_exp_f32 v165, v165
    v_exp_f32 v166, v166
    v_mfma_f32_32x32x16_bf16 v[112:127], a[64:67], v[104:107], v[112:127]
    ds_read_b128 v[200:203], v10 offset:6144
    ds_read_b128 v[204:207], v10 offset:7168
    v_exp_f32 v167, v167
    v_exp_f32 v168, v168
    v_mfma_f32_32x32x16_bf16 v[112:127], a[68:71], v[108:111], v[112:127]
    v_cvt_pk_bf16_f32 v128, v128, v129
    v_cvt_pk_bf16_f32 v129, v130, v131
    v_cvt_pk_bf16_f32 v130, v132, v133
    v_cvt_pk_bf16_f32 v131, v134, v135
    v_cvt_pk_bf16_f32 v132, v136, v137
    v_cvt_pk_bf16_f32 v133, v138, v139
    v_cvt_pk_bf16_f32 v134, v140, v141
    v_cvt_pk_bf16_f32 v135, v142, v143
    v_exp_f32 v169, v169
    v_exp_f32 v170, v170
    v_exp_f32 v171, v171
    v_exp_f32 v172, v172
    v_exp_f32 v173, v173
    v_exp_f32 v174, v174
    v_exp_f32_e64 v175, v175
    v_add_u32 v0, 0x14830, v1
    v_pk_fma_f32 v[160:161], v[160:161], s[34:35], s[34:35]
    v_pk_fma_f32 v[162:163], v[162:163], s[34:35], s[34:35]
    v_pk_fma_f32 v[164:165], v[164:165], s[34:35], s[34:35]
    v_pk_fma_f32 v[166:167], v[166:167], s[34:35], s[34:35]
    v_pk_fma_f32 v[168:169], v[168:169], s[34:35], s[34:35]
    v_pk_fma_f32 v[170:171], v[170:171], s[34:35], s[34:35]
    v_pk_fma_f32 v[172:173], v[172:173], s[34:35], s[34:35]
    v_pk_fma_f32 v[174:175], v[174:175], s[34:35], s[34:35]
    s_waitcnt lgkmcnt(0)
    v_mfma_f32_32x32x16_bf16 v[176:191], a[144:147], v[128:131], v[176:191]
    ds_read_b128 v[208:211], v10 offset:8192
    ds_read_b128 v[212:215], v10 offset:9216
    v_rcp_f32 v160, v160
    v_rcp_f32_e64 v161, v161
    v_mfma_f32_32x32x16_bf16 v[176:191], a[156:159], v[132:135], v[176:191]
    ds_read_b128 v[216:219], v10 offset:10240
    ds_read_b128 v[220:223], v10 offset:11264
    v_rcp_f32 v162, v162
    v_rcp_f32 v163, v163
    v_mfma_f32_32x32x16_bf16 v[192:207], a[148:151], v[128:131], v[192:207]
    ds_read_b128 v[12:15], v0
    ds_read_b128 v[16:19], v0 offset:1024
    v_rcp_f32 v164, v164
    v_rcp_f32 v165, v165
    v_mfma_f32_32x32x16_bf16 v[192:207], a[160:163], v[132:135], v[192:207]
    ds_read_b128 v[20:23], v0 offset:2048
    ds_read_b128 v[24:27], v0 offset:3072
    s_waitcnt lgkmcnt(4)
    v_rcp_f32 v166, v166
    v_rcp_f32 v167, v167
    v_mfma_f32_32x32x16_bf16 v[208:223], a[152:155], v[128:131], v[208:223]
    v_rcp_f32 v168, v168
    v_rcp_f32 v169, v169
    v_rcp_f32 v170, v170
    v_mfma_f32_32x32x16_bf16 v[208:223], a[164:167], v[132:135], v[208:223]
    s_waitcnt lgkmcnt(0)
    v_rcp_f32 v171, v171
    v_rcp_f32 v172, v172
    v_rcp_f32 v173, v173
    v_rcp_f32 v174, v174
    v_rcp_f32 v175, v175
    v_pk_mul_f32 v[160:161], v[160:161], v[144:145]
    v_pk_mul_f32 v[162:163], v[162:163], v[146:147]
    v_pk_mul_f32 v[164:165], v[164:165], v[148:149]
    v_pk_mul_f32 v[166:167], v[166:167], v[150:151]
    v_pk_mul_f32 v[168:169], v[168:169], v[152:153]
    v_pk_mul_f32 v[170:171], v[170:171], v[154:155]
    v_pk_mul_f32 v[172:173], v[172:173], v[156:157]
    v_pk_mul_f32 v[174:175], v[174:175], v[158:159]
    v_pk_fma_f32 v[128:129], v[112:113], v[112:113], s[32:33]
    v_pk_fma_f32 v[130:131], v[114:115], v[114:115], s[32:33]
    v_pk_fma_f32 v[132:133], v[116:117], v[116:117], s[32:33]
    v_pk_fma_f32 v[134:135], v[118:119], v[118:119], s[32:33]
    v_pk_fma_f32 v[136:137], v[120:121], v[120:121], s[32:33]
    v_pk_fma_f32 v[138:139], v[122:123], v[122:123], s[32:33]
    v_pk_fma_f32 v[140:141], v[124:125], v[124:125], s[32:33]
    v_pk_fma_f32 v[142:143], v[126:127], v[126:127], s[32:33]
    v_pk_mul_f32 v[128:129], v[128:129], v[112:113] neg_lo:[1,0] neg_hi:[1,0]
    v_pk_mul_f32 v[130:131], v[130:131], v[114:115] neg_lo:[1,0] neg_hi:[1,0]
    v_pk_mul_f32 v[132:133], v[132:133], v[116:117] neg_lo:[1,0] neg_hi:[1,0]
    v_pk_mul_f32 v[134:135], v[134:135], v[118:119] neg_lo:[1,0] neg_hi:[1,0]
    v_pk_mul_f32 v[136:137], v[136:137], v[120:121] neg_lo:[1,0] neg_hi:[1,0]
    v_pk_mul_f32 v[138:139], v[138:139], v[122:123] neg_lo:[1,0] neg_hi:[1,0]
    v_pk_mul_f32 v[140:141], v[140:141], v[124:125] neg_lo:[1,0] neg_hi:[1,0]
    v_pk_mul_f32 v[142:143], v[142:143], v[126:127] neg_lo:[1,0] neg_hi:[1,0]
    v_pk_add_f32 v[12:13], v[12:13], v[16:17]
    v_pk_add_f32 v[14:15], v[14:15], v[18:19]
    v_pk_add_f32 v[20:21], v[20:21], v[24:25]
    v_pk_add_f32 v[22:23], v[22:23], v[26:27]
    v_pk_add_f32 v[12:13], v[12:13], v[20:21]
    v_pk_add_f32 v[14:15], v[14:15], v[22:23]
    v_pk_mul_f32 v[12:13], v[12:13], s[36:37]
    v_pk_mul_f32 v[14:15], v[14:15], s[36:37]
    v_pk_fma_f32 v[14:15], v[12:13], v[12:13], v[14:15] neg_lo:[1,0,0] neg_hi:[1,0,0]
    v_max_f32 v14, 0, v14
    v_max_f32 v15, 0, v15
    v_pk_add_f32 v[14:15], v[14:15], s[38:39]
    v_mfma_f32_32x32x16_bf16 v[144:159], a[72:75], v[88:91], 0
    s_mov_b32 m0, s42
    v_rsq_f32 v14, v14
    v_rsq_f32 v15, v15
    v_exp_f32 v128, v128
    v_mfma_f32_32x32x16_bf16 v[144:159], a[76:79], v[92:95], v[144:159]
    buffer_load_dwordx4 v32, s[16:19], 0 offen lds
    v_cvt_pk_bf16_f32 v160, v160, v161
    v_exp_f32 v129, v129
    v_exp_f32 v130, v130
    v_mfma_f32_32x32x16_bf16 v[144:159], a[80:83], v[96:99], v[144:159]
    v_exp_f32 v131, v131
    v_exp_f32 v132, v132
    v_exp_f32_e64 v133, v133
    v_mfma_f32_32x32x16_bf16 v[144:159], a[84:87], v[100:103], v[144:159]
    buffer_load_dwordx4 v33, s[16:19], 0 offen offset:1024 lds
    v_cvt_pk_bf16_f32 v161, v162, v163
    v_exp_f32 v134, v134
    v_exp_f32 v135, v135
    v_mfma_f32_32x32x16_bf16 v[144:159], a[88:91], v[104:107], v[144:159]
    v_exp_f32 v136, v136
    v_exp_f32 v137, v137
    v_exp_f32_e64 v138, v138
    v_mfma_f32_32x32x16_bf16 v[144:159], a[92:95], v[108:111], v[144:159]
    buffer_load_dwordx4 v34, s[16:19], 0 offen offset:2048 lds
    v_cvt_pk_bf16_f32 v162, v164, v165
    v_cvt_pk_bf16_f32 v163, v166, v167
    v_exp_f32 v139, v139
    v_exp_f32 v140, v140
    v_exp_f32 v141, v141
    v_exp_f32 v142, v142
    v_exp_f32_e64 v143, v143
    v_subrev_u32 v36, 0x80, v36
    v_pk_fma_f32 v[128:129], v[128:129], s[34:35], s[34:35]
    v_pk_fma_f32 v[130:131], v[130:131], s[34:35], s[34:35]
    v_pk_fma_f32 v[132:133], v[132:133], s[34:35], s[34:35]
    v_pk_fma_f32 v[134:135], v[134:135], s[34:35], s[34:35]
    v_pk_fma_f32 v[136:137], v[136:137], s[34:35], s[34:35]
    v_pk_fma_f32 v[138:139], v[138:139], s[34:35], s[34:35]
    v_pk_fma_f32 v[140:141], v[140:141], s[34:35], s[34:35]
    v_pk_fma_f32 v[142:143], v[142:143], s[34:35], s[34:35]
    v_pk_mul_f32 v[28:29], v[14:15], s[34:35]
    v_pk_mul_f32 v[30:31], v[12:13], v[28:29] neg_lo:[1,0] neg_hi:[1,0]
    v_pk_fma_f32 v[40:41], v[40:41], v[28:29], v[30:31] op_sel:[0,0,0] op_sel_hi:[1,0,0]
    v_pk_fma_f32 v[42:43], v[42:43], v[28:29], v[30:31] op_sel:[0,0,0] op_sel_hi:[1,0,0]
    v_pk_fma_f32 v[44:45], v[44:45], v[28:29], v[30:31] op_sel:[0,1,1] op_sel_hi:[1,1,1]
    v_pk_fma_f32 v[46:47], v[46:47], v[28:29], v[30:31] op_sel:[0,1,1] op_sel_hi:[1,1,1]
    v_pk_fma_f32 v[48:49], v[48:49], v[28:29], v[30:31] op_sel:[0,0,0] op_sel_hi:[1,0,0]
    v_pk_fma_f32 v[50:51], v[50:51], v[28:29], v[30:31] op_sel:[0,0,0] op_sel_hi:[1,0,0]
    v_pk_fma_f32 v[52:53], v[52:53], v[28:29], v[30:31] op_sel:[0,1,1] op_sel_hi:[1,1,1]
    v_pk_fma_f32 v[54:55], v[54:55], v[28:29], v[30:31] op_sel:[0,1,1] op_sel_hi:[1,1,1]
    v_pk_fma_f32 v[56:57], v[56:57], v[28:29], v[30:31] op_sel:[0,0,0] op_sel_hi:[1,0,0]
    v_pk_fma_f32 v[58:59], v[58:59], v[28:29], v[30:31] op_sel:[0,0,0] op_sel_hi:[1,0,0]
    v_pk_fma_f32 v[60:61], v[60:61], v[28:29], v[30:31] op_sel:[0,1,1] op_sel_hi:[1,1,1]
    v_pk_fma_f32 v[62:63], v[62:63], v[28:29], v[30:31] op_sel:[0,1,1] op_sel_hi:[1,1,1]
    v_mfma_f32_32x32x16_bf16 v[176:191], a[168:171], v[160:163], v[176:191]
    v_cvt_pk_bf16_f32 v164, v168, v169
    v_cvt_pk_bf16_f32 v165, v170, v171
    v_cvt_pk_bf16_f32 v166, v172, v173
    v_cvt_pk_bf16_f32 v167, v174, v175
    v_rcp_f32 v128, v128
    v_mfma_f32_32x32x16_bf16 v[192:207], a[172:175], v[160:163], v[192:207]
    buffer_load_dwordx4 v35, s[16:19], 0 offen offset:3072 lds
    v_rcp_f32 v129, v129
    v_rcp_f32 v130, v130
    v_mfma_f32_32x32x16_bf16 v[208:223], a[176:179], v[160:163], v[208:223]
    v_rcp_f32 v131, v131
    v_rcp_f32 v132, v132
    v_rcp_f32 v133, v133
    v_mfma_f32_32x32x16_bf16 v[176:191], a[180:183], v[164:167], v[176:191]
    buffer_load_dwordx4 v36, s[16:19], 0 offen offset:3200 lds
    v_rcp_f32 v134, v134
    v_rcp_f32 v135, v135
    v_rcp_f32 v136, v136
    v_mfma_f32_32x32x16_bf16 v[192:207], a[184:187], v[164:167], v[192:207]
    s_add_u32 m0, s42, 0x1080
    v_rcp_f32 v137, v137
    v_rcp_f32 v138, v138
    v_rcp_f32 v139, v139
    v_mfma_f32_32x32x16_bf16 v[208:223], a[188:191], v[164:167], v[208:223]
    buffer_load_dwordx4 v32, s[28:31], 0 offen lds
    v_rcp_f32 v140, v140
    v_rcp_f32 v141, v141
    v_rcp_f32 v142, v142
    v_rcp_f32 v143, v143
    v_pk_mul_f32 v[128:129], v[128:129], v[112:113]
    v_pk_mul_f32 v[130:131], v[130:131], v[114:115]
    v_pk_mul_f32 v[132:133], v[132:133], v[116:117]
    v_pk_mul_f32 v[134:135], v[134:135], v[118:119]
    v_pk_mul_f32 v[136:137], v[136:137], v[120:121]
    v_pk_mul_f32 v[138:139], v[138:139], v[122:123]
    v_pk_mul_f32 v[140:141], v[140:141], v[124:125]
    v_pk_mul_f32 v[142:143], v[142:143], v[126:127]
    v_pk_fma_f32 v[160:161], v[144:145], v[144:145], s[32:33]
    v_pk_fma_f32 v[162:163], v[146:147], v[146:147], s[32:33]
    v_pk_fma_f32 v[164:165], v[148:149], v[148:149], s[32:33]
    v_pk_fma_f32 v[166:167], v[150:151], v[150:151], s[32:33]
    v_pk_fma_f32 v[168:169], v[152:153], v[152:153], s[32:33]
    v_pk_fma_f32 v[170:171], v[154:155], v[154:155], s[32:33]
    v_pk_fma_f32 v[172:173], v[156:157], v[156:157], s[32:33]
    v_pk_fma_f32 v[174:175], v[158:159], v[158:159], s[32:33]
    v_pk_mul_f32 v[160:161], v[160:161], v[144:145] neg_lo:[1,0] neg_hi:[1,0]
    v_pk_mul_f32 v[162:163], v[162:163], v[146:147] neg_lo:[1,0] neg_hi:[1,0]
    v_pk_mul_f32 v[164:165], v[164:165], v[148:149] neg_lo:[1,0] neg_hi:[1,0]
    v_pk_mul_f32 v[166:167], v[166:167], v[150:151] neg_lo:[1,0] neg_hi:[1,0]
    v_pk_mul_f32 v[168:169], v[168:169], v[152:153] neg_lo:[1,0] neg_hi:[1,0]
    v_pk_mul_f32 v[170:171], v[170:171], v[154:155] neg_lo:[1,0] neg_hi:[1,0]
    v_pk_mul_f32 v[172:173], v[172:173], v[156:157] neg_lo:[1,0] neg_hi:[1,0]
    v_pk_mul_f32 v[174:175], v[174:175], v[158:159] neg_lo:[1,0] neg_hi:[1,0]
    v_pk_fma_f32 v[64:65], v[64:65], v[28:29], v[30:31] op_sel:[0,0,0] op_sel_hi:[1,0,0]
    v_pk_fma_f32 v[66:67], v[66:67], v[28:29], v[30:31] op_sel:[0,0,0] op_sel_hi:[1,0,0]
    v_pk_fma_f32 v[68:69], v[68:69], v[28:29], v[30:31] op_sel:[0,1,1] op_sel_hi:[1,1,1]
    v_pk_fma_f32 v[70:71], v[70:71], v[28:29], v[30:31] op_sel:[0,1,1] op_sel_hi:[1,1,1]
    v_pk_fma_f32 v[72:73], v[72:73], v[28:29], v[30:31] op_sel:[0,0,0] op_sel_hi:[1,0,0]
    v_pk_fma_f32 v[74:75], v[74:75], v[28:29], v[30:31] op_sel:[0,0,0] op_sel_hi:[1,0,0]
    v_pk_fma_f32 v[76:77], v[76:77], v[28:29], v[30:31] op_sel:[0,1,1] op_sel_hi:[1,1,1]
    v_pk_fma_f32 v[78:79], v[78:79], v[28:29], v[30:31] op_sel:[0,1,1] op_sel_hi:[1,1,1]
    v_pk_fma_f32 v[80:81], v[80:81], v[28:29], v[30:31] op_sel:[0,0,0] op_sel_hi:[1,0,0]
    v_pk_fma_f32 v[82:83], v[82:83], v[28:29], v[30:31] op_sel:[0,0,0] op_sel_hi:[1,0,0]
    v_pk_fma_f32 v[84:85], v[84:85], v[28:29], v[30:31] op_sel:[0,1,1] op_sel_hi:[1,1,1]
    v_pk_fma_f32 v[86:87], v[86:87], v[28:29], v[30:31] op_sel:[0,1,1] op_sel_hi:[1,1,1]
    v_mfma_f32_32x32x16_bf16 v[112:127], a[96:99], v[88:91], 0
    buffer_load_dwordx4 v33, s[28:31], 0 offen offset:1024 lds
    v_cvt_pk_bf16_f32 v128, v128, v129
    v_exp_f32 v160, v160
    v_exp_f32 v161, v161
    v_mfma_f32_32x32x16_bf16 v[112:127], a[100:103], v[92:95], v[112:127]
    v_exp_f32 v162, v162
    v_exp_f32 v163, v163
    v_exp_f32_e64 v164, v164
    v_cvt_pk_bf16_f32 v40, v40, v41
    v_cvt_pk_bf16_f32 v41, v42, v43
    v_cvt_pk_bf16_f32 v42, v48, v49
    v_cvt_pk_bf16_f32 v43, v50, v51
    v_mfma_f32_32x32x16_bf16 v[112:127], a[104:107], v[96:99], v[112:127]
    ds_write_b128 v7, v[40:43]
    v_cvt_pk_bf16_f32 v129, v130, v131
    v_mfma_f32_32x32x16_bf16 v[112:127], a[108:111], v[100:103], v[112:127]
    buffer_load_dwordx4 v34, s[28:31], 0 offen offset:2048 lds
    v_cvt_pk_bf16_f32 v130, v132, v133
    v_exp_f32 v165, v165
    v_exp_f32 v166, v166
    v_cvt_pk_bf16_f32 v44, v44, v45
    v_cvt_pk_bf16_f32 v45, v46, v47
    v_cvt_pk_bf16_f32 v46, v52, v53
    v_cvt_pk_bf16_f32 v47, v54, v55
    v_mfma_f32_32x32x16_bf16 v[112:127], a[112:115], v[104:107], v[112:127]
    ds_write_b128 v7, v[44:47] offset:32
    v_cvt_pk_bf16_f32 v131, v134, v135
    v_mfma_f32_32x32x16_bf16 v[112:127], a[116:119], v[108:111], v[112:127]
    buffer_load_dwordx4 v35, s[28:31], 0 offen offset:3072 lds
    v_cvt_pk_bf16_f32 v56, v56, v57
    v_cvt_pk_bf16_f32 v57, v58, v59
    v_cvt_pk_bf16_f32 v58, v64, v65
    v_cvt_pk_bf16_f32 v59, v66, v67
    v_exp_f32 v167, v167
    v_exp_f32 v168, v168
    v_exp_f32 v169, v169
    v_exp_f32 v170, v170
    v_exp_f32 v171, v171
    v_exp_f32 v172, v172
    v_exp_f32 v173, v173
    v_exp_f32 v174, v174
    v_exp_f32_e64 v175, v175
    v_pk_fma_f32 v[160:161], v[160:161], s[34:35], s[34:35]
    v_pk_fma_f32 v[162:163], v[162:163], s[34:35], s[34:35]
    v_pk_fma_f32 v[164:165], v[164:165], s[34:35], s[34:35]
    v_pk_fma_f32 v[166:167], v[166:167], s[34:35], s[34:35]
    v_pk_fma_f32 v[168:169], v[168:169], s[34:35], s[34:35]
    v_pk_fma_f32 v[170:171], v[170:171], s[34:35], s[34:35]
    v_pk_fma_f32 v[172:173], v[172:173], s[34:35], s[34:35]
    v_pk_fma_f32 v[174:175], v[174:175], s[34:35], s[34:35]
    v_mfma_f32_32x32x16_bf16 v[176:191], a[192:195], v[128:131], v[176:191]
    ds_write_b128 v7, v[56:59] offset:512
    v_cvt_pk_bf16_f32 v60, v60, v61
    v_mfma_f32_32x32x16_bf16 v[192:207], a[196:199], v[128:131], v[192:207]
    v_cvt_pk_bf16_f32 v132, v136, v137
    v_cvt_pk_bf16_f32 v133, v138, v139
    v_cvt_pk_bf16_f32 v134, v140, v141
    v_cvt_pk_bf16_f32 v135, v142, v143
    v_rcp_f32_e64 v160, v160
    v_cvt_pk_bf16_f32 v61, v62, v63
    v_cvt_pk_bf16_f32 v62, v68, v69
    v_cvt_pk_bf16_f32 v63, v70, v71
    v_mfma_f32_32x32x16_bf16 v[208:223], a[200:203], v[128:131], v[208:223]
    ds_write_b128 v7, v[60:63] offset:544
    v_cvt_pk_bf16_f32 v72, v72, v73
    v_mfma_f32_32x32x16_bf16 v[176:191], a[204:207], v[132:135], v[176:191]
    buffer_load_dwordx4 v36, s[28:31], 0 offen offset:3200 lds
    v_cvt_pk_bf16_f32 v73, v74, v75
    v_rcp_f32 v161, v161
    v_rcp_f32 v162, v162
    v_cvt_pk_bf16_f32 v74, v80, v81
    v_cvt_pk_bf16_f32 v75, v82, v83
    v_mfma_f32_32x32x16_bf16 v[192:207], a[208:211], v[132:135], v[192:207]
    ds_write_b128 v7, v[72:75] offset:1024
    v_cvt_pk_bf16_f32 v76, v76, v77
    v_mfma_f32_32x32x16_bf16 v[208:223], a[212:215], v[132:135], v[208:223]
    buffer_load_dwordx4 v[12:15], v8, s[20:23], 0 offen
    v_cvt_pk_bf16_f32 v77, v78, v79
    v_cvt_pk_bf16_f32 v78, v84, v85
    v_cvt_pk_bf16_f32 v79, v86, v87
    v_rcp_f32 v163, v163
    v_rcp_f32 v164, v164
    v_rcp_f32 v165, v165
    v_rcp_f32 v166, v166
    v_rcp_f32 v167, v167
    v_rcp_f32 v168, v168
    v_rcp_f32 v169, v169
    v_rcp_f32 v170, v170
    v_rcp_f32 v171, v171
    v_rcp_f32 v172, v172
    v_rcp_f32 v173, v173
    v_rcp_f32 v174, v174
    v_rcp_f32_e64 v175, v175
    v_pk_mul_f32 v[160:161], v[160:161], v[144:145]
    v_pk_mul_f32 v[162:163], v[162:163], v[146:147]
    v_pk_mul_f32 v[164:165], v[164:165], v[148:149]
    v_pk_mul_f32 v[166:167], v[166:167], v[150:151]
    v_pk_mul_f32 v[168:169], v[168:169], v[152:153]
    v_pk_mul_f32 v[170:171], v[170:171], v[154:155]
    v_pk_mul_f32 v[172:173], v[172:173], v[156:157]
    v_pk_mul_f32 v[174:175], v[174:175], v[158:159]
    v_pk_fma_f32 v[128:129], v[112:113], v[112:113], s[32:33]
    v_pk_fma_f32 v[130:131], v[114:115], v[114:115], s[32:33]
    v_pk_fma_f32 v[132:133], v[116:117], v[116:117], s[32:33]
    v_pk_fma_f32 v[134:135], v[118:119], v[118:119], s[32:33]
    v_pk_fma_f32 v[136:137], v[120:121], v[120:121], s[32:33]
    v_pk_fma_f32 v[138:139], v[122:123], v[122:123], s[32:33]
    v_pk_fma_f32 v[140:141], v[124:125], v[124:125], s[32:33]
    v_pk_fma_f32 v[142:143], v[126:127], v[126:127], s[32:33]
    v_pk_mul_f32 v[128:129], v[128:129], v[112:113] neg_lo:[1,0] neg_hi:[1,0]
    v_pk_mul_f32 v[130:131], v[130:131], v[114:115] neg_lo:[1,0] neg_hi:[1,0]
    v_pk_mul_f32 v[132:133], v[132:133], v[116:117] neg_lo:[1,0] neg_hi:[1,0]
    v_pk_mul_f32 v[134:135], v[134:135], v[118:119] neg_lo:[1,0] neg_hi:[1,0]
    v_pk_mul_f32 v[136:137], v[136:137], v[120:121] neg_lo:[1,0] neg_hi:[1,0]
    v_pk_mul_f32 v[138:139], v[138:139], v[122:123] neg_lo:[1,0] neg_hi:[1,0]
    v_pk_mul_f32 v[140:141], v[140:141], v[124:125] neg_lo:[1,0] neg_hi:[1,0]
    v_pk_mul_f32 v[142:143], v[142:143], v[126:127] neg_lo:[1,0] neg_hi:[1,0]
    v_mfma_f32_32x32x16_bf16 v[144:159], a[120:123], v[88:91], 0
    buffer_load_dwordx4 v[16:19], v8, s[20:23], 0 offen offset:32
    v_cvt_pk_bf16_f32 v160, v160, v161
    v_exp_f32 v128, v128
    v_exp_f32 v129, v129
    v_mfma_f32_32x32x16_bf16 v[144:159], a[124:127], v[92:95], v[144:159]
    s_add_u32 s42, s42, 0x8480
    v_exp_f32 v130, v130
    v_exp_f32 v131, v131
    v_exp_f32_e64 v132, v132
    v_mfma_f32_32x32x16_bf16 v[144:159], a[128:131], v[96:99], v[144:159]
    ds_write_b128 v7, v[76:79] offset:1056
    v_cvt_pk_bf16_f32 v161, v162, v163
    v_mfma_f32_32x32x16_bf16 v[144:159], a[132:135], v[100:103], v[144:159]
    s_sub_u32 s61, s42, 0xe7e0
    v_exp_f32 v133, v133
    v_exp_f32 v134, v134
    v_exp_f32_e64 v135, v135
    v_mfma_f32_32x32x16_bf16 v[144:159], a[136:139], v[104:107], v[144:159]
    buffer_load_dwordx4 v[20:23], v8, s[20:23], 0 offen offset:64
    v_cvt_pk_bf16_f32 v162, v164, v165
    v_exp_f32 v136, v136
    v_exp_f32 v137, v137
    v_mfma_f32_32x32x16_bf16 v[144:159], a[140:143], v[108:111], v[144:159]
    s_min_u32 s42, s42, s61
    v_cvt_pk_bf16_f32 v163, v166, v167
    v_exp_f32 v138, v138
    v_exp_f32 v139, v139
    v_exp_f32 v140, v140
    v_exp_f32 v141, v141
    v_exp_f32 v142, v142
    v_exp_f32 v143, v143
    v_add_u32 v0, s46, v1
    v_mov_b32_e64 v10, 0
    v_pk_fma_f32 v[128:129], v[128:129], s[34:35], s[34:35]
    v_pk_fma_f32 v[130:131], v[130:131], s[34:35], s[34:35]
    v_pk_fma_f32 v[132:133], v[132:133], s[34:35], s[34:35]
    v_pk_fma_f32 v[134:135], v[134:135], s[34:35], s[34:35]
    v_pk_fma_f32 v[136:137], v[136:137], s[34:35], s[34:35]
    v_pk_fma_f32 v[138:139], v[138:139], s[34:35], s[34:35]
    v_pk_fma_f32 v[140:141], v[140:141], s[34:35], s[34:35]
    v_pk_fma_f32 v[142:143], v[142:143], s[34:35], s[34:35]
    v_mfma_f32_32x32x16_bf16 v[176:191], a[216:219], v[160:163], v[176:191]
    s_waitcnt lgkmcnt(0)
    s_barrier
    v_cvt_pk_bf16_f32 v164, v168, v169
    v_cvt_pk_bf16_f32 v165, v170, v171
    v_cvt_pk_bf16_f32 v166, v172, v173
    v_cvt_pk_bf16_f32 v167, v174, v175
    v_mfma_f32_32x32x16_bf16 v[192:207], a[220:223], v[160:163], v[192:207]
    ds_read_b128 v[88:91], v0
    ds_read_b128 v[92:95], v0 offset:1024
    v_rcp_f32 v128, v128
    v_rcp_f32 v129, v129
    v_mfma_f32_32x32x16_bf16 v[208:223], a[224:227], v[160:163], v[208:223]
    ds_read_b128 v[96:99], v0 offset:2048
    ds_read_b128 v[100:103], v0 offset:3072
    v_rcp_f32 v130, v130
    v_rcp_f32 v131, v131
    v_mfma_f32_32x32x16_bf16 v[176:191], a[228:231], v[164:167], v[176:191]
    ds_read_b128 v[104:107], v0 offset:4096
    ds_read_b128 v[108:111], v0 offset:5120
    v_rcp_f32 v132, v132
    v_rcp_f32 v133, v133
    v_mfma_f32_32x32x16_bf16 v[192:207], a[232:235], v[164:167], v[192:207]
    buffer_load_dwordx4 v[24:27], v8, s[20:23], 0 offen offset:96
    v_rcp_f32 v134, v134
    v_rcp_f32 v135, v135
    v_rcp_f32 v136, v136
    v_mfma_f32_32x32x16_bf16 v[208:223], a[236:239], v[164:167], v[208:223]
    s_waitcnt lgkmcnt(0)
    v_rcp_f32 v137, v137
    v_rcp_f32 v138, v138
    v_rcp_f32 v139, v139
    v_rcp_f32 v140, v140
    v_rcp_f32 v141, v141
    v_rcp_f32 v142, v142
    v_rcp_f32_e64 v143, v143
    v_pk_mul_f32 v[128:129], v[128:129], v[112:113]
    v_pk_mul_f32 v[130:131], v[130:131], v[114:115]
    v_pk_mul_f32 v[132:133], v[132:133], v[116:117]
    v_pk_mul_f32 v[134:135], v[134:135], v[118:119]
    v_pk_mul_f32 v[136:137], v[136:137], v[120:121]
    v_pk_mul_f32 v[138:139], v[138:139], v[122:123]
    v_pk_mul_f32 v[140:141], v[140:141], v[124:125]
    v_pk_mul_f32 v[142:143], v[142:143], v[126:127]
    v_pk_fma_f32 v[160:161], v[144:145], v[144:145], s[32:33]
    v_pk_fma_f32 v[162:163], v[146:147], v[146:147], s[32:33]
    v_pk_fma_f32 v[164:165], v[148:149], v[148:149], s[32:33]
    v_pk_fma_f32 v[166:167], v[150:151], v[150:151], s[32:33]
    v_pk_fma_f32 v[168:169], v[152:153], v[152:153], s[32:33]
    v_pk_fma_f32 v[170:171], v[154:155], v[154:155], s[32:33]
    v_pk_fma_f32 v[172:173], v[156:157], v[156:157], s[32:33]
    v_pk_fma_f32 v[174:175], v[158:159], v[158:159], s[32:33]
    v_pk_mul_f32 v[160:161], v[160:161], v[144:145] neg_lo:[1,0] neg_hi:[1,0]
    v_pk_mul_f32 v[162:163], v[162:163], v[146:147] neg_lo:[1,0] neg_hi:[1,0]
    v_pk_mul_f32 v[164:165], v[164:165], v[148:149] neg_lo:[1,0] neg_hi:[1,0]
    v_pk_mul_f32 v[166:167], v[166:167], v[150:151] neg_lo:[1,0] neg_hi:[1,0]
    v_pk_mul_f32 v[168:169], v[168:169], v[152:153] neg_lo:[1,0] neg_hi:[1,0]
    v_pk_mul_f32 v[170:171], v[170:171], v[154:155] neg_lo:[1,0] neg_hi:[1,0]
    v_pk_mul_f32 v[172:173], v[172:173], v[156:157] neg_lo:[1,0] neg_hi:[1,0]
    v_pk_mul_f32 v[174:175], v[174:175], v[158:159] neg_lo:[1,0] neg_hi:[1,0]
    v_mfma_f32_32x32x16_bf16 v[112:127], a[0:3], v[88:91], 0
    buffer_load_dwordx4 v[28:31], v8, s[20:23], 0 offen offset:128
    ds_read_b128 v[40:43], v10 offset:59360
    v_exp_f32 v160, v160
    v_exp_f32 v161, v161
    v_mfma_f32_32x32x16_bf16 v[112:127], a[4:7], v[92:95], v[112:127]
    s_add_u32 s43, s43, s55
    v_exp_f32 v162, v162
    v_exp_f32 v163, v163
    v_exp_f32 v164, v164
    v_mfma_f32_32x32x16_bf16 v[112:127], a[8:11], v[96:99], v[112:127]
    s_add_u32 s16, s16, s55
    v_exp_f32 v165, v165
    v_exp_f32 v166, v166
    v_exp_f32 v167, v167
    v_mfma_f32_32x32x16_bf16 v[112:127], a[12:15], v[100:103], v[112:127]
    s_addc_u32 s17, s17, s3
    v_exp_f32 v168, v168
    v_exp_f32 v169, v169
    v_exp_f32 v170, v170
    v_mfma_f32_32x32x16_bf16 v[112:127], a[16:19], v[104:107], v[112:127]
    buffer_load_dwordx4 v[32:35], v8, s[20:23], 0 offen offset:160
    ds_read_b128 v[44:47], v10 offset:59360
    v_exp_f32 v171, v171
    v_exp_f32_e64 v172, v172
    v_mfma_f32_32x32x16_bf16 v[112:127], a[20:23], v[108:111], v[112:127]
    s_waitcnt vmcnt(3)
    v_cvt_pk_bf16_f32 v128, v128, v129
    v_cvt_pk_bf16_f32 v129, v130, v131
    v_cvt_pk_bf16_f32 v130, v132, v133
    v_cvt_pk_bf16_f32 v131, v134, v135
    v_exp_f32 v173, v173
    v_exp_f32 v174, v174
    v_exp_f32 v175, v175
    v_add_u32 v2, 0x8480, v2
    v_subrev_u32 v11, 0xe7e0, v2
    v_min_u32 v2, v2, v11
    v_add_u32 v3, 0x8480, v3
    v_subrev_u32 v11, 0xe7e0, v3
    v_min_u32_e64 v3, v3, v11
    v_pk_fma_f32 v[160:161], v[160:161], s[34:35], s[34:35]
    v_pk_fma_f32 v[162:163], v[162:163], s[34:35], s[34:35]
    v_pk_fma_f32 v[164:165], v[164:165], s[34:35], s[34:35]
    v_pk_fma_f32 v[166:167], v[166:167], s[34:35], s[34:35]
    v_pk_fma_f32 v[168:169], v[168:169], s[34:35], s[34:35]
    v_pk_fma_f32 v[170:171], v[170:171], s[34:35], s[34:35]
    v_pk_fma_f32 v[172:173], v[172:173], s[34:35], s[34:35]
    v_pk_fma_f32 v[174:175], v[174:175], s[34:35], s[34:35]
    v_dot2_f32_bf16 v176, v12, s51, v176
    v_dot2_f32_bf16 v177, v12, s52, v177
    v_dot2_f32_bf16 v178, v13, s51, v178
    v_dot2_f32_bf16 v179, v13, s52, v179
    v_dot2_f32_bf16 v180, v14, s51, v180
    v_dot2_f32_bf16 v181, v14, s52, v181
    v_dot2_f32_bf16 v182, v15, s51, v182
    v_dot2_f32_bf16 v183, v15, s52, v183
    v_dot2_f32_bf16 v184, v16, s51, v184
    v_dot2_f32_bf16 v185, v16, s52, v185
    v_dot2_f32_bf16 v186, v17, s51, v186
    v_dot2_f32_bf16 v187, v17, s52, v187
    v_dot2_f32_bf16 v188, v18, s51, v188
    v_dot2_f32_bf16 v189, v18, s52, v189
    v_dot2_f32_bf16 v190, v19, s51, v190
    v_dot2_f32_bf16 v191, v19, s52, v191
    v_dot2_f32_bf16 v192, v20, s51, v192
    v_dot2_f32_bf16 v193, v20, s52, v193
    v_dot2_f32_bf16 v194, v21, s51, v194
    v_dot2_f32_bf16 v195, v21, s52, v195
    v_dot2_f32_bf16 v196, v22, s51, v196
    v_dot2_f32_bf16 v197, v22, s52, v197
    v_dot2_f32_bf16 v198, v23, s51, v198
    v_dot2_f32_bf16 v199, v23, s52, v199
    v_mfma_f32_32x32x16_bf16 v[176:191], a[240:243], v[128:131], v[176:191]
    ds_read_b128 v[48:51], v10 offset:59360
    s_add_u32 s28, s28, s55
    v_cvt_pk_bf16_f32 v132, v136, v137
    v_cvt_pk_bf16_f32 v133, v138, v139
    v_cvt_pk_bf16_f32 v134, v140, v141
    v_cvt_pk_bf16_f32 v135, v142, v143
    v_rcp_f32 v160, v160
    v_mfma_f32_32x32x16_bf16 v[192:207], a[244:247], v[128:131], v[192:207]
    ds_read_b128 v[52:55], v10 offset:59360
    s_addc_u32 s29, s29, s3
    v_rcp_f32 v161, v161
    v_rcp_f32 v162, v162
    v_rcp_f32 v163, v163
    v_mfma_f32_32x32x16_bf16 v[208:223], a[248:251], v[128:131], v[208:223]
    ds_read_b128 v[56:59], v10 offset:59360
    s_add_u32 s20, s20, s55
    v_rcp_f32 v164, v164
    v_rcp_f32 v165, v165
    v_rcp_f32 v166, v166
    v_mfma_f32_32x32x16_bf16 v[176:191], a[252:255], v[132:135], v[176:191]
    ds_read_b128 v[60:63], v10 offset:59360
    s_addc_u32 s21, s21, s3
    v_rcp_f32 v167, v167
    v_rcp_f32 v168, v168
    v_mfma_f32_32x32x16_bf16 v[192:207], v[224:227], v[132:135], v[192:207]
    s_sub_u32 s41, s41, 1
    v_rcp_f32 v169, v169
    v_rcp_f32 v170, v170
    v_rcp_f32 v171, v171
    v_mfma_f32_32x32x16_bf16 v[208:223], v[228:231], v[132:135], v[208:223]
    s_waitcnt vmcnt(0)
    v_rcp_f32 v172, v172
    v_rcp_f32 v173, v173
    v_rcp_f32 v174, v174
    v_rcp_f32_e64 v175, v175
    s_cbranch_scc1 L_last
    v_pk_mul_f32 v[160:161], v[160:161], v[144:145]
    v_pk_mul_f32 v[162:163], v[162:163], v[146:147]
    v_pk_mul_f32 v[164:165], v[164:165], v[148:149]
    v_pk_mul_f32 v[166:167], v[166:167], v[150:151]
    v_pk_mul_f32 v[168:169], v[168:169], v[152:153]
    v_pk_mul_f32 v[170:171], v[170:171], v[154:155]
    v_pk_mul_f32 v[172:173], v[172:173], v[156:157]
    v_pk_mul_f32 v[174:175], v[174:175], v[158:159]
    v_dot2_f32_bf16 v200, v24, s51, v200
    v_dot2_f32_bf16 v201, v24, s52, v201
    v_dot2_f32_bf16 v202, v25, s51, v202
    v_dot2_f32_bf16 v203, v25, s52, v203
    v_dot2_f32_bf16 v204, v26, s51, v204
    v_dot2_f32_bf16 v205, v26, s52, v205
    v_dot2_f32_bf16 v206, v27, s51, v206
    v_dot2_f32_bf16 v207, v27, s52, v207
    v_dot2_f32_bf16 v208, v28, s51, v208
    v_dot2_f32_bf16 v209, v28, s52, v209
    v_dot2_f32_bf16 v210, v29, s51, v210
    v_dot2_f32_bf16 v211, v29, s52, v211
    v_dot2_f32_bf16 v212, v30, s51, v212
    v_dot2_f32_bf16 v213, v30, s52, v213
    v_dot2_f32_bf16 v214, v31, s51, v214
    v_dot2_f32_bf16 v215, v31, s52, v215
    v_dot2_f32_bf16 v216, v32, s51, v216
    v_dot2_f32_bf16 v217, v32, s52, v217
    v_dot2_f32_bf16 v218, v33, s51, v218
    v_dot2_f32_bf16 v219, v33, s52, v219
    v_dot2_f32_bf16 v220, v34, s51, v220
    v_dot2_f32_bf16 v221, v34, s52, v221
    v_dot2_f32_bf16 v222, v35, s51, v222
    v_dot2_f32_bf16 v223, v35, s52, v223
    v_pk_fma_f32 v[128:129], v[112:113], v[112:113], s[32:33]
    v_pk_fma_f32 v[130:131], v[114:115], v[114:115], s[32:33]
    v_pk_fma_f32 v[132:133], v[116:117], v[116:117], s[32:33]
    v_pk_fma_f32 v[134:135], v[118:119], v[118:119], s[32:33]
    v_pk_fma_f32 v[136:137], v[120:121], v[120:121], s[32:33]
    v_pk_fma_f32 v[138:139], v[122:123], v[122:123], s[32:33]
    v_pk_fma_f32 v[140:141], v[124:125], v[124:125], s[32:33]
    v_pk_fma_f32 v[142:143], v[126:127], v[126:127], s[32:33]
    v_pk_mul_f32 v[128:129], v[128:129], v[112:113] neg_lo:[1,0] neg_hi:[1,0]
    v_pk_mul_f32 v[130:131], v[130:131], v[114:115] neg_lo:[1,0] neg_hi:[1,0]
    v_pk_mul_f32 v[132:133], v[132:133], v[116:117] neg_lo:[1,0] neg_hi:[1,0]
    v_pk_mul_f32 v[134:135], v[134:135], v[118:119] neg_lo:[1,0] neg_hi:[1,0]
    v_pk_mul_f32 v[136:137], v[136:137], v[120:121] neg_lo:[1,0] neg_hi:[1,0]
    v_pk_mul_f32 v[138:139], v[138:139], v[122:123] neg_lo:[1,0] neg_hi:[1,0]
    v_pk_mul_f32 v[140:141], v[140:141], v[124:125] neg_lo:[1,0] neg_hi:[1,0]
    v_pk_mul_f32 v[142:143], v[142:143], v[126:127] neg_lo:[1,0] neg_hi:[1,0]
    v_mfma_f32_32x32x16_bf16 v[144:159], a[24:27], v[88:91], 0
    s_barrier
    v_cvt_pk_bf16_f32 v160, v160, v161
    v_exp_f32 v128, v128
    v_mfma_f32_32x32x16_bf16 v[144:159], a[28:31], v[92:95], v[144:159]
    ds_read2_b32 v[32:33], v4 offset0:0 offset1:1
    ds_read2_b32 v[34:35], v4 offset0:8 offset1:9
    v_exp_f32 v129, v129
    v_exp_f32 v130, v130
    v_mfma_f32_32x32x16_bf16 v[144:159], a[32:35], v[96:99], v[144:159]
    ds_read2_b64 v[12:15], v2 offset0:0 offset1:132
    ds_read2_b64 v[16:19], v2 offset0:72 offset1:204
    v_exp_f32 v131, v131
    v_exp_f32 v132, v132
    v_mfma_f32_32x32x16_bf16 v[144:159], a[36:39], v[100:103], v[144:159]
    ds_read2_b64 v[20:23], v2 offset0:12 offset1:144
    ds_read2_b32 v[36:37], v4 offset0:4 offset1:5
    v_exp_f32 v133, v133
    v_exp_f32 v134, v134
    v_mfma_f32_32x32x16_bf16 v[144:159], a[40:43], v[104:107], v[144:159]
    ds_read2_b32 v[38:39], v4 offset0:12 offset1:13
    ds_read2_b64 v[24:27], v2 offset0:84 offset1:216
    v_exp_f32 v135, v135
    v_exp_f32 v136, v136
    v_mfma_f32_32x32x16_bf16 v[144:159], a[44:47], v[108:111], v[144:159]
    ds_read2_b64 v[28:31], v2 offset0:24 offset1:156
    v_cvt_pk_bf16_f32 v161, v162, v163
    v_cvt_pk_bf16_f32 v162, v164, v165
    v_cvt_pk_bf16_f32 v163, v166, v167
    v_exp_f32 v137, v137
    v_exp_f32 v138, v138
    v_exp_f32 v139, v139
    v_exp_f32 v140, v140
    v_exp_f32 v141, v141
    v_exp_f32 v142, v142
    v_exp_f32_e64 v143, v143
    v_pk_fma_f32 v[128:129], v[128:129], s[34:35], s[34:35]
    v_pk_fma_f32 v[130:131], v[130:131], s[34:35], s[34:35]
    v_pk_fma_f32 v[132:133], v[132:133], s[34:35], s[34:35]
    v_pk_fma_f32 v[134:135], v[134:135], s[34:35], s[34:35]
    v_pk_fma_f32 v[136:137], v[136:137], s[34:35], s[34:35]
    v_pk_fma_f32 v[138:139], v[138:139], s[34:35], s[34:35]
    v_pk_fma_f32 v[140:141], v[140:141], s[34:35], s[34:35]
    v_pk_fma_f32 v[142:143], v[142:143], s[34:35], s[34:35]
    v_mfma_f32_32x32x16_bf16 v[176:191], v[232:235], v[160:163], v[176:191]
    s_waitcnt lgkmcnt(0)
    v_cvt_pk_bf16_f32 v164, v168, v169
    v_cvt_pk_bf16_f32 v165, v170, v171
    v_cvt_pk_bf16_f32 v166, v172, v173
    v_cvt_pk_bf16_f32 v167, v174, v175
    v_rcp_f32 v128, v128
    v_smfmac_f32_16x16x64_bf16 v[40:43], v[32:35], v[12:19], v6
    ds_read2_b64 v[12:15], v3 offset0:0 offset1:132
    v_rcp_f32 v129, v129
    v_mfma_f32_32x32x16_bf16 v[192:207], v[236:239], v[160:163], v[192:207]
    s_add_u32 s45, s45, 8
    v_rcp_f32 v130, v130
    v_rcp_f32 v131, v131
    v_rcp_f32_e64 v132, v132
    v_smfmac_f32_16x16x64_bf16 v[44:47], v[32:35], v[16:23], v6
    ds_read2_b32 v[32:33], v4 offset0:32 offset1:33
    ds_read2_b32 v[34:35], v4 offset0:40 offset1:41
    v_mfma_f32_32x32x16_bf16 v[208:223], v[240:243], v[160:163], v[208:223]
    s_cmp_lt_u32 s45, s68
    v_rcp_f32 v133, v133
    v_rcp_f32 v134, v134
    v_rcp_f32 v135, v135
    v_smfmac_f32_16x16x64_bf16 v[40:43], v[36:39], v[20:27], v6
    ds_read2_b64 v[16:19], v3 offset0:72 offset1:204
    ds_read2_b64 v[20:23], v3 offset0:12 offset1:144
    v_mfma_f32_32x32x16_bf16 v[176:191], v[244:247], v[164:167], v[176:191]
    s_cselect_b32 s30, 0x18c80, 0
    v_rcp_f32 v136, v136
    v_rcp_f32 v137, v137
    v_rcp_f32_e64 v138, v138
    v_smfmac_f32_16x16x64_bf16 v[44:47], v[36:39], v[24:31], v6
    ds_read2_b32 v[36:37], v4 offset0:36 offset1:37
    ds_read2_b32 v[38:39], v4 offset0:44 offset1:45
    v_mfma_f32_32x32x16_bf16 v[192:207], v[248:251], v[164:167], v[192:207]
    ds_read2_b64 v[24:27], v3 offset0:84 offset1:216
    v_rcp_f32 v139, v139
    v_rcp_f32 v140, v140
    v_mfma_f32_32x32x16_bf16 v[208:223], v[252:255], v[164:167], v[208:223]
    ds_read2_b64 v[28:31], v3 offset0:24 offset1:156
    v_rcp_f32 v141, v141
    v_rcp_f32 v142, v142
    v_rcp_f32 v143, v143
    v_mul_f32 v128, v128, v112
    v_mul_f32_e64 v129, v129, v113
    v_pk_mul_f32 v[130:131], v[130:131], v[114:115]
    v_pk_mul_f32 v[132:133], v[132:133], v[116:117]
    v_pk_mul_f32 v[134:135], v[134:135], v[118:119]
    v_pk_mul_f32 v[136:137], v[136:137], v[120:121]
    v_pk_mul_f32 v[138:139], v[138:139], v[122:123]
    v_pk_mul_f32 v[140:141], v[140:141], v[124:125]
    v_pk_mul_f32 v[142:143], v[142:143], v[126:127]
    v_pk_fma_f32 v[160:161], v[144:145], v[144:145], s[32:33]
    v_pk_fma_f32 v[162:163], v[146:147], v[146:147], s[32:33]
    v_pk_fma_f32 v[164:165], v[148:149], v[148:149], s[32:33]
    v_pk_fma_f32 v[166:167], v[150:151], v[150:151], s[32:33]
    v_pk_fma_f32 v[168:169], v[152:153], v[152:153], s[32:33]
    v_pk_fma_f32 v[170:171], v[154:155], v[154:155], s[32:33]
    v_pk_fma_f32 v[172:173], v[156:157], v[156:157], s[32:33]
    v_pk_fma_f32 v[174:175], v[158:159], v[158:159], s[32:33]
    v_pk_mul_f32 v[160:161], v[160:161], v[144:145] neg_lo:[1,0] neg_hi:[1,0]
    v_pk_mul_f32 v[162:163], v[162:163], v[146:147] neg_lo:[1,0] neg_hi:[1,0]
    v_pk_mul_f32 v[164:165], v[164:165], v[148:149] neg_lo:[1,0] neg_hi:[1,0]
    v_pk_mul_f32 v[166:167], v[166:167], v[150:151] neg_lo:[1,0] neg_hi:[1,0]
    v_pk_mul_f32 v[168:169], v[168:169], v[152:153] neg_lo:[1,0] neg_hi:[1,0]
    v_pk_mul_f32 v[170:171], v[170:171], v[154:155] neg_lo:[1,0] neg_hi:[1,0]
    v_pk_mul_f32 v[172:173], v[172:173], v[156:157] neg_lo:[1,0] neg_hi:[1,0]
    v_pk_mul_f32 v[174:175], v[174:175], v[158:159] neg_lo:[1,0] neg_hi:[1,0]
    v_mfma_f32_32x32x16_bf16 v[112:127], a[48:51], v[88:91], 0
    s_waitcnt lgkmcnt(0)
    v_exp_f32 v160, v160
    v_exp_f32 v161, v161
    v_exp_f32 v162, v162
    v_smfmac_f32_16x16x64_bf16 v[40:43], v[32:35], v[12:19], v6
    ds_read2_b64 v[12:15], v2 offset0:1 offset1:133
    v_lshrrev_b32 v11, 9, v1
    v_mfma_f32_32x32x16_bf16 v[112:127], a[52:55], v[92:95], v[112:127]
    v_exp_f32 v163, v163
    v_exp_f32 v164, v164
    v_exp_f32 v165, v165
    v_smfmac_f32_16x16x64_bf16 v[44:47], v[32:35], v[16:23], v6
    ds_read2_b32 v[32:33], v4 offset0:64 offset1:65
    ds_read2_b32 v[34:35], v4 offset0:72 offset1:73
    v_mfma_f32_32x32x16_bf16 v[112:127], a[56:59], v[96:99], v[112:127]
    v_exp_f32 v166, v166
    v_exp_f32 v167, v167
    v_exp_f32_e64 v168, v168
    v_smfmac_f32_16x16x64_bf16 v[40:43], v[36:39], v[20:27], v6
    ds_read2_b64 v[16:19], v2 offset0:73 offset1:205
    ds_read2_b64 v[20:23], v2 offset0:13 offset1:145
    v_mfma_f32_32x32x16_bf16 v[112:127], a[60:63], v[100:103], v[112:127]
    v_exp_f32 v169, v169
    v_exp_f32 v170, v170
    v_exp_f32_e64 v171, v171
    v_smfmac_f32_16x16x64_bf16 v[44:47], v[36:39], v[24:31], v6
    ds_read2_b32 v[36:37], v4 offset0:68 offset1:69
    ds_read2_b32 v[38:39], v4 offset0:76 offset1:77
    v_mfma_f32_32x32x16_bf16 v[112:127], a[64:67], v[104:107], v[112:127]
    ds_read2_b64 v[24:27], v2 offset0:85 offset1:217
    v_mad_u32_u24 v0, v1, 13, s48
    v_exp_f32 v172, v172
    v_exp_f32 v173, v173
    v_mfma_f32_32x32x16_bf16 v[112:127], a[68:71], v[108:111], v[112:127]
    ds_read2_b64 v[28:31], v2 offset0:25 offset1:157
    v_mad_i32_i24 v0, v11, s13, v0
    v_bfe_u32 v11, v6, 16, 12
    v_lshrrev_b32 v9, 28, v6
    v_lshl_add_u32 v9, v9, 4, v11
    v_add_u32 v9, s48, v9
    v_cvt_pk_bf16_f32 v64, v176, v177
    v_cvt_pk_bf16_f32 v65, v178, v179
    v_cvt_pk_bf16_f32 v66, v180, v181
    v_cvt_pk_bf16_f32 v67, v182, v183
    v_cvt_pk_bf16_f32 v68, v184, v185
    v_cvt_pk_bf16_f32 v69, v186, v187
    v_cvt_pk_bf16_f32 v70, v188, v189
    v_cvt_pk_bf16_f32 v71, v190, v191
    v_cvt_pk_bf16_f32 v72, v192, v193
    v_cvt_pk_bf16_f32 v73, v194, v195
    v_cvt_pk_bf16_f32 v74, v196, v197
    v_cvt_pk_bf16_f32 v75, v198, v199
    v_cvt_pk_bf16_f32 v76, v200, v201
    v_cvt_pk_bf16_f32 v77, v202, v203
    v_cvt_pk_bf16_f32 v78, v204, v205
    v_cvt_pk_bf16_f32 v79, v206, v207
    v_cvt_pk_bf16_f32 v80, v208, v209
    v_cvt_pk_bf16_f32 v81, v210, v211
    v_cvt_pk_bf16_f32 v82, v212, v213
    v_cvt_pk_bf16_f32 v83, v214, v215
    v_cvt_pk_bf16_f32 v84, v216, v217
    v_cvt_pk_bf16_f32 v85, v218, v219
    v_cvt_pk_bf16_f32 v86, v220, v221
    v_cvt_pk_bf16_f32 v87, v222, v223
    v_cvt_pk_bf16_f32 v128, v128, v129
    v_cvt_pk_bf16_f32 v129, v130, v131
    v_cvt_pk_bf16_f32 v130, v132, v133
    v_cvt_pk_bf16_f32 v131, v134, v135
    v_exp_f32 v174, v174
    v_exp_f32_e64 v175, v175
    ds_write_b128 v0, v[64:67]
    v_pk_fma_f32 v[160:161], v[160:161], s[34:35], s[34:35]
    v_pk_fma_f32 v[162:163], v[162:163], s[34:35], s[34:35]
    v_pk_fma_f32 v[164:165], v[164:165], s[34:35], s[34:35]
    v_pk_fma_f32 v[166:167], v[166:167], s[34:35], s[34:35]
    v_pk_fma_f32 v[168:169], v[168:169], s[34:35], s[34:35]
    v_pk_fma_f32 v[170:171], v[170:171], s[34:35], s[34:35]
    v_pk_fma_f32 v[172:173], v[172:173], s[34:35], s[34:35]
    v_pk_fma_f32 v[174:175], v[174:175], s[34:35], s[34:35]
    v_mfma_f32_32x32x16_bf16 v[176:191], a[144:147], v[128:131], 0
    s_waitcnt lgkmcnt(0)
    v_cvt_pk_bf16_f32 v132, v136, v137
    v_cvt_pk_bf16_f32 v133, v138, v139
    v_cvt_pk_bf16_f32 v134, v140, v141
    v_cvt_pk_bf16_f32 v135, v142, v143
    v_rcp_f32 v160, v160
    v_smfmac_f32_16x16x64_bf16 v[48:51], v[32:35], v[12:19], v6
    ds_read2_b64 v[12:15], v3 offset0:1 offset1:133
    v_rcp_f32 v161, v161
    v_mfma_f32_32x32x16_bf16 v[192:207], a[148:151], v[128:131], 0
    v_rcp_f32 v162, v162
    v_rcp_f32 v163, v163
    v_rcp_f32_e64 v164, v164
    v_smfmac_f32_16x16x64_bf16 v[52:55], v[32:35], v[16:23], v6
    ds_read2_b32 v[32:33], v4 offset0:96 offset1:97
    ds_read2_b32 v[34:35], v4 offset0:104 offset1:105
    v_mfma_f32_32x32x16_bf16 v[208:223], a[152:155], v[128:131], 0
    s_cselect_b32 s6, 0x3000000, 0
    v_rcp_f32 v165, v165
    v_rcp_f32 v166, v166
    v_rcp_f32_e64 v167, v167
    v_smfmac_f32_16x16x64_bf16 v[48:51], v[36:39], v[20:27], v6
    ds_read2_b64 v[16:19], v3 offset0:73 offset1:205
    ds_read2_b64 v[20:23], v3 offset0:13 offset1:145
    v_mfma_f32_32x32x16_bf16 v[176:191], a[156:159], v[132:135], v[176:191]
    v_rcp_f32 v168, v168
    v_rcp_f32 v169, v169
    v_rcp_f32_e64 v170, v170
    v_smfmac_f32_16x16x64_bf16 v[52:55], v[36:39], v[24:31], v6
    ds_read2_b32 v[36:37], v4 offset0:100 offset1:101
    ds_read2_b32 v[38:39], v4 offset0:108 offset1:109
    v_mfma_f32_32x32x16_bf16 v[192:207], a[160:163], v[132:135], v[192:207]
    ds_read2_b64 v[24:27], v3 offset0:85 offset1:217
    v_rcp_f32 v171, v171
    v_rcp_f32 v172, v172
    v_rcp_f32_e64 v173, v173
    v_mfma_f32_32x32x16_bf16 v[208:223], a[164:167], v[132:135], v[208:223]
    ds_read2_b64 v[28:31], v3 offset0:25 offset1:157
    ds_write_b128 v0, v[68:71] offset:32
    v_rcp_f32 v174, v174
    v_rcp_f32 v175, v175
    s_branch L_loop
.p2align 6
L_last:
    v_pk_mul_f32 v[160:161], v[160:161], v[144:145]
    v_pk_mul_f32 v[162:163], v[162:163], v[146:147]
    v_pk_mul_f32 v[164:165], v[164:165], v[148:149]
    v_pk_mul_f32 v[166:167], v[166:167], v[150:151]
    v_pk_mul_f32 v[168:169], v[168:169], v[152:153]
    v_pk_mul_f32 v[170:171], v[170:171], v[154:155]
    v_pk_mul_f32 v[172:173], v[172:173], v[156:157]
    v_pk_mul_f32 v[174:175], v[174:175], v[158:159]
    v_dot2_f32_bf16 v200, v24, s51, v200
    v_dot2_f32_bf16 v201, v24, s52, v201
    v_dot2_f32_bf16 v202, v25, s51, v202
    v_dot2_f32_bf16 v203, v25, s52, v203
    v_dot2_f32_bf16 v204, v26, s51, v204
    v_dot2_f32_bf16 v205, v26, s52, v205
    v_dot2_f32_bf16 v206, v27, s51, v206
    v_dot2_f32_bf16 v207, v27, s52, v207
    v_dot2_f32_bf16 v208, v28, s51, v208
    v_dot2_f32_bf16 v209, v28, s52, v209
    v_dot2_f32_bf16 v210, v29, s51, v210
    v_dot2_f32_bf16 v211, v29, s52, v211
    v_dot2_f32_bf16 v212, v30, s51, v212
    v_dot2_f32_bf16 v213, v30, s52, v213
    v_dot2_f32_bf16 v214, v31, s51, v214
    v_dot2_f32_bf16 v215, v31, s52, v215
    v_dot2_f32_bf16 v216, v32, s51, v216
    v_dot2_f32_bf16 v217, v32, s52, v217
    v_dot2_f32_bf16 v218, v33, s51, v218
    v_dot2_f32_bf16 v219, v33, s52, v219
    v_dot2_f32_bf16 v220, v34, s51, v220
    v_dot2_f32_bf16 v221, v34, s52, v221
    v_dot2_f32_bf16 v222, v35, s51, v222
    v_dot2_f32_bf16 v223, v35, s52, v223
    v_pk_fma_f32 v[128:129], v[112:113], v[112:113], s[32:33]
    v_pk_fma_f32 v[130:131], v[114:115], v[114:115], s[32:33]
    v_pk_fma_f32 v[132:133], v[116:117], v[116:117], s[32:33]
    v_pk_fma_f32 v[134:135], v[118:119], v[118:119], s[32:33]
    v_pk_fma_f32 v[136:137], v[120:121], v[120:121], s[32:33]
    v_pk_fma_f32 v[138:139], v[122:123], v[122:123], s[32:33]
    v_pk_fma_f32 v[140:141], v[124:125], v[124:125], s[32:33]
    v_pk_fma_f32 v[142:143], v[126:127], v[126:127], s[32:33]
    v_pk_mul_f32 v[128:129], v[128:129], v[112:113] neg_lo:[1,0] neg_hi:[1,0]
    v_pk_mul_f32 v[130:131], v[130:131], v[114:115] neg_lo:[1,0] neg_hi:[1,0]
    v_pk_mul_f32 v[132:133], v[132:133], v[116:117] neg_lo:[1,0] neg_hi:[1,0]
    v_pk_mul_f32 v[134:135], v[134:135], v[118:119] neg_lo:[1,0] neg_hi:[1,0]
    v_pk_mul_f32 v[136:137], v[136:137], v[120:121] neg_lo:[1,0] neg_hi:[1,0]
    v_pk_mul_f32 v[138:139], v[138:139], v[122:123] neg_lo:[1,0] neg_hi:[1,0]
    v_pk_mul_f32 v[140:141], v[140:141], v[124:125] neg_lo:[1,0] neg_hi:[1,0]
    v_pk_mul_f32 v[142:143], v[142:143], v[126:127] neg_lo:[1,0] neg_hi:[1,0]
    v_mfma_f32_32x32x16_bf16 v[144:159], a[24:27], v[88:91], 0
    v_exp_f32 v128, v128
    v_exp_f32 v129, v129
    v_exp_f32 v130, v130
    v_mfma_f32_32x32x16_bf16 v[144:159], a[28:31], v[92:95], v[144:159]
    v_exp_f32 v131, v131
    v_exp_f32 v132, v132
    v_exp_f32 v133, v133
    v_mfma_f32_32x32x16_bf16 v[144:159], a[32:35], v[96:99], v[144:159]
    v_exp_f32 v134, v134
    v_exp_f32 v135, v135
    v_exp_f32 v136, v136
    v_mfma_f32_32x32x16_bf16 v[144:159], a[36:39], v[100:103], v[144:159]
    v_exp_f32 v137, v137
    v_exp_f32 v138, v138
    v_exp_f32 v139, v139
    v_mfma_f32_32x32x16_bf16 v[144:159], a[40:43], v[104:107], v[144:159]
    v_exp_f32 v140, v140
    v_exp_f32 v141, v141
    v_exp_f32_e64 v142, v142
    v_mfma_f32_32x32x16_bf16 v[144:159], a[44:47], v[108:111], v[144:159]
    v_cvt_pk_bf16_f32 v160, v160, v161
    v_cvt_pk_bf16_f32 v161, v162, v163
    v_cvt_pk_bf16_f32 v162, v164, v165
    v_cvt_pk_bf16_f32 v163, v166, v167
    v_exp_f32_e64 v143, v143
    v_fma_f32 v128, v128, s34, s34
    v_fma_f32 v129, v129, s34, s34
    v_fma_f32 v130, v130, s34, s34
    v_fma_f32 v131, v131, s34, s34
    v_pk_fma_f32 v[132:133], v[132:133], s[34:35], s[34:35]
    v_pk_fma_f32 v[134:135], v[134:135], s[34:35], s[34:35]
    v_pk_fma_f32 v[136:137], v[136:137], s[34:35], s[34:35]
    v_pk_fma_f32 v[138:139], v[138:139], s[34:35], s[34:35]
    v_pk_fma_f32 v[140:141], v[140:141], s[34:35], s[34:35]
    v_pk_fma_f32 v[142:143], v[142:143], s[34:35], s[34:35]
    v_mfma_f32_32x32x16_bf16 v[176:191], v[232:235], v[160:163], v[176:191]
    v_cvt_pk_bf16_f32 v164, v168, v169
    v_cvt_pk_bf16_f32 v165, v170, v171
    v_cvt_pk_bf16_f32 v166, v172, v173
    v_cvt_pk_bf16_f32 v167, v174, v175
    v_rcp_f32 v128, v128
    v_mfma_f32_32x32x16_bf16 v[192:207], v[236:239], v[160:163], v[192:207]
    v_rcp_f32 v129, v129
    v_rcp_f32 v130, v130
    v_rcp_f32 v131, v131
    v_mfma_f32_32x32x16_bf16 v[208:223], v[240:243], v[160:163], v[208:223]
    v_rcp_f32 v132, v132
    v_rcp_f32 v133, v133
    v_rcp_f32 v134, v134
    v_mfma_f32_32x32x16_bf16 v[176:191], v[244:247], v[164:167], v[176:191]
    v_rcp_f32 v135, v135
    v_rcp_f32 v136, v136
    v_rcp_f32 v137, v137
    v_mfma_f32_32x32x16_bf16 v[192:207], v[248:251], v[164:167], v[192:207]
    v_rcp_f32 v138, v138
    v_rcp_f32 v139, v139
    v_rcp_f32 v140, v140
    v_mfma_f32_32x32x16_bf16 v[208:223], v[252:255], v[164:167], v[208:223]
    v_rcp_f32 v141, v141
    v_rcp_f32 v142, v142
    v_rcp_f32 v143, v143
    v_mul_f32 v128, v128, v112
    v_mul_f32 v129, v129, v113
    v_mul_f32 v130, v130, v114
    v_mul_f32 v131, v131, v115
    v_pk_mul_f32 v[132:133], v[132:133], v[116:117]
    v_pk_mul_f32 v[134:135], v[134:135], v[118:119]
    v_pk_mul_f32 v[136:137], v[136:137], v[120:121]
    v_pk_mul_f32 v[138:139], v[138:139], v[122:123]
    v_pk_mul_f32 v[140:141], v[140:141], v[124:125]
    v_pk_mul_f32 v[142:143], v[142:143], v[126:127]
    v_pk_fma_f32 v[160:161], v[144:145], v[144:145], s[32:33]
    v_pk_fma_f32 v[162:163], v[146:147], v[146:147], s[32:33]
    v_pk_fma_f32 v[164:165], v[148:149], v[148:149], s[32:33]
    v_pk_fma_f32 v[166:167], v[150:151], v[150:151], s[32:33]
    v_pk_fma_f32 v[168:169], v[152:153], v[152:153], s[32:33]
    v_pk_fma_f32 v[170:171], v[154:155], v[154:155], s[32:33]
    v_pk_fma_f32 v[172:173], v[156:157], v[156:157], s[32:33]
    v_pk_fma_f32 v[174:175], v[158:159], v[158:159], s[32:33]
    v_pk_mul_f32 v[160:161], v[160:161], v[144:145] neg_lo:[1,0] neg_hi:[1,0]
    v_pk_mul_f32 v[162:163], v[162:163], v[146:147] neg_lo:[1,0] neg_hi:[1,0]
    v_pk_mul_f32 v[164:165], v[164:165], v[148:149] neg_lo:[1,0] neg_hi:[1,0]
    v_pk_mul_f32 v[166:167], v[166:167], v[150:151] neg_lo:[1,0] neg_hi:[1,0]
    v_pk_mul_f32 v[168:169], v[168:169], v[152:153] neg_lo:[1,0] neg_hi:[1,0]
    v_pk_mul_f32 v[170:171], v[170:171], v[154:155] neg_lo:[1,0] neg_hi:[1,0]
    v_pk_mul_f32 v[172:173], v[172:173], v[156:157] neg_lo:[1,0] neg_hi:[1,0]
    v_pk_mul_f32 v[174:175], v[174:175], v[158:159] neg_lo:[1,0] neg_hi:[1,0]
    v_mfma_f32_32x32x16_bf16 v[112:127], a[48:51], v[88:91], 0
    v_exp_f32 v160, v160
    v_exp_f32 v161, v161
    v_exp_f32 v162, v162
    v_mfma_f32_32x32x16_bf16 v[112:127], a[52:55], v[92:95], v[112:127]
    v_exp_f32 v163, v163
    v_exp_f32 v164, v164
    v_exp_f32 v165, v165
    v_mfma_f32_32x32x16_bf16 v[112:127], a[56:59], v[96:99], v[112:127]
    v_exp_f32 v166, v166
    v_exp_f32 v167, v167
    v_exp_f32 v168, v168
    v_mfma_f32_32x32x16_bf16 v[112:127], a[60:63], v[100:103], v[112:127]
    v_exp_f32 v169, v169
    v_exp_f32 v170, v170
    v_exp_f32 v171, v171
    v_lshrrev_b32_e64 v11, 9, v1
    v_mad_u32_u24 v0, v1, 13, s48
    v_mad_i32_i24 v0, v11, s13, v0
    v_bfe_u32 v11, v6, 16, 12
    v_lshrrev_b32 v9, 28, v6
    v_lshl_add_u32 v9, v9, 4, v11
    v_add_u32 v9, s48, v9
    v_cvt_pk_bf16_f32 v64, v176, v177
    v_cvt_pk_bf16_f32 v65, v178, v179
    v_cvt_pk_bf16_f32 v66, v180, v181
    v_cvt_pk_bf16_f32 v67, v182, v183
    v_mfma_f32_32x32x16_bf16 v[112:127], a[64:67], v[104:107], v[112:127]
    ds_write_b128 v0, v[64:67]
    v_cvt_pk_bf16_f32 v68, v184, v185
    v_mfma_f32_32x32x16_bf16 v[112:127], a[68:71], v[108:111], v[112:127]
    v_cvt_pk_bf16_f32 v69, v186, v187
    v_cvt_pk_bf16_f32 v70, v188, v189
    v_cvt_pk_bf16_f32 v71, v190, v191
    v_cvt_pk_bf16_f32 v72, v192, v193
    v_cvt_pk_bf16_f32 v73, v194, v195
    v_cvt_pk_bf16_f32 v74, v196, v197
    v_cvt_pk_bf16_f32 v75, v198, v199
    v_cvt_pk_bf16_f32 v76, v200, v201
    v_cvt_pk_bf16_f32 v77, v202, v203
    v_cvt_pk_bf16_f32 v78, v204, v205
    v_cvt_pk_bf16_f32 v79, v206, v207
    v_cvt_pk_bf16_f32 v80, v208, v209
    v_cvt_pk_bf16_f32 v81, v210, v211
    v_cvt_pk_bf16_f32 v82, v212, v213
    v_cvt_pk_bf16_f32 v83, v214, v215
    v_cvt_pk_bf16_f32 v84, v216, v217
    v_cvt_pk_bf16_f32 v85, v218, v219
    v_cvt_pk_bf16_f32 v86, v220, v221
    v_cvt_pk_bf16_f32 v87, v222, v223
    v_cvt_pk_bf16_f32 v128, v128, v129
    v_cvt_pk_bf16_f32 v129, v130, v131
    v_cvt_pk_bf16_f32 v130, v132, v133
    v_cvt_pk_bf16_f32 v131, v134, v135
    v_exp_f32 v172, v172
    v_exp_f32 v173, v173
    v_exp_f32 v174, v174
    v_exp_f32 v175, v175
    v_pk_fma_f32 v[160:161], v[160:161], s[34:35], s[34:35]
    v_pk_fma_f32 v[162:163], v[162:163], s[34:35], s[34:35]
    v_pk_fma_f32 v[164:165], v[164:165], s[34:35], s[34:35]
    v_pk_fma_f32 v[166:167], v[166:167], s[34:35], s[34:35]
    v_pk_fma_f32 v[168:169], v[168:169], s[34:35], s[34:35]
    v_pk_fma_f32 v[170:171], v[170:171], s[34:35], s[34:35]
    v_pk_fma_f32 v[172:173], v[172:173], s[34:35], s[34:35]
    v_pk_fma_f32 v[174:175], v[174:175], s[34:35], s[34:35]
    v_mfma_f32_32x32x16_bf16 v[176:191], a[144:147], v[128:131], 0
    v_cvt_pk_bf16_f32 v132, v136, v137
    v_cvt_pk_bf16_f32 v133, v138, v139
    v_cvt_pk_bf16_f32 v134, v140, v141
    v_cvt_pk_bf16_f32 v135, v142, v143
    v_rcp_f32 v160, v160
    v_mfma_f32_32x32x16_bf16 v[192:207], a[148:151], v[128:131], 0
    v_rcp_f32 v161, v161
    v_rcp_f32 v162, v162
    v_rcp_f32 v163, v163
    v_mfma_f32_32x32x16_bf16 v[208:223], a[152:155], v[128:131], 0
    v_rcp_f32 v164, v164
    v_rcp_f32 v165, v165
    v_rcp_f32 v166, v166
    v_mfma_f32_32x32x16_bf16 v[176:191], a[156:159], v[132:135], v[176:191]
    v_rcp_f32 v167, v167
    v_rcp_f32 v168, v168
    v_rcp_f32 v169, v169
    v_mfma_f32_32x32x16_bf16 v[192:207], a[160:163], v[132:135], v[192:207]
    v_rcp_f32 v170, v170
    v_rcp_f32 v171, v171
    v_rcp_f32 v172, v172
    v_mfma_f32_32x32x16_bf16 v[208:223], a[164:167], v[132:135], v[208:223]
    ds_write_b128 v0, v[68:71] offset:32
    v_rcp_f32 v173, v173
    v_rcp_f32 v174, v174
    v_rcp_f32 v175, v175
    v_pk_mul_f32 v[160:161], v[160:161], v[144:145]
    v_pk_mul_f32 v[162:163], v[162:163], v[146:147]
    v_pk_mul_f32 v[164:165], v[164:165], v[148:149]
    v_pk_mul_f32 v[166:167], v[166:167], v[150:151]
    v_pk_mul_f32 v[168:169], v[168:169], v[152:153]
    v_pk_mul_f32 v[170:171], v[170:171], v[154:155]
    v_pk_mul_f32 v[172:173], v[172:173], v[156:157]
    v_pk_mul_f32 v[174:175], v[174:175], v[158:159]
    v_pk_fma_f32 v[128:129], v[112:113], v[112:113], s[32:33]
    v_pk_fma_f32 v[130:131], v[114:115], v[114:115], s[32:33]
    v_pk_fma_f32 v[132:133], v[116:117], v[116:117], s[32:33]
    v_pk_fma_f32 v[134:135], v[118:119], v[118:119], s[32:33]
    v_pk_fma_f32 v[136:137], v[120:121], v[120:121], s[32:33]
    v_pk_fma_f32 v[138:139], v[122:123], v[122:123], s[32:33]
    v_pk_fma_f32 v[140:141], v[124:125], v[124:125], s[32:33]
    v_pk_fma_f32 v[142:143], v[126:127], v[126:127], s[32:33]
    v_pk_mul_f32 v[128:129], v[128:129], v[112:113] neg_lo:[1,0] neg_hi:[1,0]
    v_pk_mul_f32 v[130:131], v[130:131], v[114:115] neg_lo:[1,0] neg_hi:[1,0]
    v_pk_mul_f32 v[132:133], v[132:133], v[116:117] neg_lo:[1,0] neg_hi:[1,0]
    v_pk_mul_f32 v[134:135], v[134:135], v[118:119] neg_lo:[1,0] neg_hi:[1,0]
    v_pk_mul_f32 v[136:137], v[136:137], v[120:121] neg_lo:[1,0] neg_hi:[1,0]
    v_pk_mul_f32 v[138:139], v[138:139], v[122:123] neg_lo:[1,0] neg_hi:[1,0]
    v_pk_mul_f32 v[140:141], v[140:141], v[124:125] neg_lo:[1,0] neg_hi:[1,0]
    v_pk_mul_f32 v[142:143], v[142:143], v[126:127] neg_lo:[1,0] neg_hi:[1,0]
    v_mfma_f32_32x32x16_bf16 v[144:159], a[72:75], v[88:91], 0
    ds_read_b128 v[64:67], v9
    ds_read_b128 v[68:71], v9 offset:3328
    v_exp_f32 v128, v128
    v_exp_f32 v129, v129
    v_mfma_f32_32x32x16_bf16 v[144:159], a[76:79], v[92:95], v[144:159]
    v_exp_f32 v130, v130
    v_exp_f32 v131, v131
    v_exp_f32 v132, v132
    v_mfma_f32_32x32x16_bf16 v[144:159], a[80:83], v[96:99], v[144:159]
    v_exp_f32 v133, v133
    v_exp_f32 v134, v134
    v_exp_f32 v135, v135
    v_mfma_f32_32x32x16_bf16 v[144:159], a[84:87], v[100:103], v[144:159]
    v_exp_f32 v136, v136
    v_exp_f32 v137, v137
    v_exp_f32 v138, v138
    v_mfma_f32_32x32x16_bf16 v[144:159], a[88:91], v[104:107], v[144:159]
    v_exp_f32 v139, v139
    v_exp_f32 v140, v140
    v_exp_f32 v141, v141
    v_mfma_f32_32x32x16_bf16 v[144:159], a[92:95], v[108:111], v[144:159]
    ds_write_b128 v0, v[72:75] offset:64
    v_cvt_pk_bf16_f32 v160, v160, v161
    v_cvt_pk_bf16_f32 v161, v162, v163
    v_cvt_pk_bf16_f32 v162, v164, v165
    v_cvt_pk_bf16_f32 v163, v166, v167
    v_exp_f32 v142, v142
    v_exp_f32 v143, v143
    v_pk_fma_f32 v[128:129], v[128:129], s[34:35], s[34:35]
    v_pk_fma_f32 v[130:131], v[130:131], s[34:35], s[34:35]
    v_pk_fma_f32 v[132:133], v[132:133], s[34:35], s[34:35]
    v_pk_fma_f32 v[134:135], v[134:135], s[34:35], s[34:35]
    v_pk_fma_f32 v[136:137], v[136:137], s[34:35], s[34:35]
    v_pk_fma_f32 v[138:139], v[138:139], s[34:35], s[34:35]
    v_pk_fma_f32 v[140:141], v[140:141], s[34:35], s[34:35]
    v_pk_fma_f32 v[142:143], v[142:143], s[34:35], s[34:35]
    v_mfma_f32_32x32x16_bf16 v[176:191], a[168:171], v[160:163], v[176:191]
    v_cvt_pk_bf16_f32 v164, v168, v169
    v_cvt_pk_bf16_f32 v165, v170, v171
    v_cvt_pk_bf16_f32 v166, v172, v173
    v_cvt_pk_bf16_f32 v167, v174, v175
    v_rcp_f32 v128, v128
    v_mfma_f32_32x32x16_bf16 v[192:207], a[172:175], v[160:163], v[192:207]
    s_waitcnt lgkmcnt(2)
    buffer_store_dwordx4 v[64:67], v11, s[24:27], 0 offen sc1 nt
    v_rcp_f32 v129, v129
    v_rcp_f32 v130, v130
    v_rcp_f32 v131, v131
    v_mfma_f32_32x32x16_bf16 v[208:223], a[176:179], v[160:163], v[208:223]
    v_rcp_f32 v132, v132
    v_rcp_f32 v133, v133
    v_rcp_f32 v134, v134
    v_mfma_f32_32x32x16_bf16 v[176:191], a[180:183], v[164:167], v[176:191]
    s_waitcnt lgkmcnt(1)
    buffer_store_dwordx4 v[68:71], v11, s[8:11], 0 offen sc1 nt
    v_rcp_f32 v135, v135
    v_rcp_f32 v136, v136
    v_rcp_f32 v137, v137
    v_mfma_f32_32x32x16_bf16 v[192:207], a[184:187], v[164:167], v[192:207]
    v_rcp_f32 v138, v138
    v_rcp_f32 v139, v139
    v_rcp_f32 v140, v140
    v_mfma_f32_32x32x16_bf16 v[208:223], a[188:191], v[164:167], v[208:223]
    ds_write_b128 v0, v[76:79] offset:96
    v_rcp_f32 v141, v141
    v_rcp_f32 v142, v142
    v_rcp_f32 v143, v143
    v_pk_mul_f32 v[128:129], v[128:129], v[112:113]
    v_pk_mul_f32 v[130:131], v[130:131], v[114:115]
    v_pk_mul_f32 v[132:133], v[132:133], v[116:117]
    v_pk_mul_f32 v[134:135], v[134:135], v[118:119]
    v_pk_mul_f32 v[136:137], v[136:137], v[120:121]
    v_pk_mul_f32 v[138:139], v[138:139], v[122:123]
    v_pk_mul_f32 v[140:141], v[140:141], v[124:125]
    v_pk_mul_f32 v[142:143], v[142:143], v[126:127]
    v_pk_fma_f32 v[160:161], v[144:145], v[144:145], s[32:33]
    v_pk_fma_f32 v[162:163], v[146:147], v[146:147], s[32:33]
    v_pk_fma_f32 v[164:165], v[148:149], v[148:149], s[32:33]
    v_pk_fma_f32 v[166:167], v[150:151], v[150:151], s[32:33]
    v_pk_fma_f32 v[168:169], v[152:153], v[152:153], s[32:33]
    v_pk_fma_f32 v[170:171], v[154:155], v[154:155], s[32:33]
    v_pk_fma_f32 v[172:173], v[156:157], v[156:157], s[32:33]
    v_pk_fma_f32 v[174:175], v[158:159], v[158:159], s[32:33]
    v_pk_mul_f32 v[160:161], v[160:161], v[144:145] neg_lo:[1,0] neg_hi:[1,0]
    v_pk_mul_f32 v[162:163], v[162:163], v[146:147] neg_lo:[1,0] neg_hi:[1,0]
    v_pk_mul_f32 v[164:165], v[164:165], v[148:149] neg_lo:[1,0] neg_hi:[1,0]
    v_pk_mul_f32 v[166:167], v[166:167], v[150:151] neg_lo:[1,0] neg_hi:[1,0]
    v_pk_mul_f32 v[168:169], v[168:169], v[152:153] neg_lo:[1,0] neg_hi:[1,0]
    v_pk_mul_f32 v[170:171], v[170:171], v[154:155] neg_lo:[1,0] neg_hi:[1,0]
    v_pk_mul_f32 v[172:173], v[172:173], v[156:157] neg_lo:[1,0] neg_hi:[1,0]
    v_pk_mul_f32 v[174:175], v[174:175], v[158:159] neg_lo:[1,0] neg_hi:[1,0]
    v_mfma_f32_32x32x16_bf16 v[112:127], a[96:99], v[88:91], 0
    ds_read_b128 v[72:75], v9 offset:64
    ds_read_b128 v[76:79], v9 offset:3392
    v_exp_f32 v160, v160
    v_exp_f32 v161, v161
    v_mfma_f32_32x32x16_bf16 v[112:127], a[100:103], v[92:95], v[112:127]
    v_exp_f32 v162, v162
    v_exp_f32 v163, v163
    v_exp_f32 v164, v164
    v_mfma_f32_32x32x16_bf16 v[112:127], a[104:107], v[96:99], v[112:127]
    v_exp_f32 v165, v165
    v_exp_f32 v166, v166
    v_exp_f32 v167, v167
    v_mfma_f32_32x32x16_bf16 v[112:127], a[108:111], v[100:103], v[112:127]
    v_exp_f32 v168, v168
    v_exp_f32 v169, v169
    v_exp_f32 v170, v170
    v_mfma_f32_32x32x16_bf16 v[112:127], a[112:115], v[104:107], v[112:127]
    v_exp_f32 v171, v171
    v_exp_f32 v172, v172
    v_exp_f32 v173, v173
    v_mfma_f32_32x32x16_bf16 v[112:127], a[116:119], v[108:111], v[112:127]
    ds_write_b128 v0, v[80:83] offset:128
    v_cvt_pk_bf16_f32 v128, v128, v129
    v_cvt_pk_bf16_f32 v129, v130, v131
    v_cvt_pk_bf16_f32 v130, v132, v133
    v_cvt_pk_bf16_f32 v131, v134, v135
    v_exp_f32 v174, v174
    v_exp_f32 v175, v175
    v_pk_fma_f32 v[160:161], v[160:161], s[34:35], s[34:35]
    v_pk_fma_f32 v[162:163], v[162:163], s[34:35], s[34:35]
    v_pk_fma_f32 v[164:165], v[164:165], s[34:35], s[34:35]
    v_pk_fma_f32 v[166:167], v[166:167], s[34:35], s[34:35]
    v_pk_fma_f32 v[168:169], v[168:169], s[34:35], s[34:35]
    v_pk_fma_f32 v[170:171], v[170:171], s[34:35], s[34:35]
    v_pk_fma_f32 v[172:173], v[172:173], s[34:35], s[34:35]
    v_pk_fma_f32 v[174:175], v[174:175], s[34:35], s[34:35]
    v_mfma_f32_32x32x16_bf16 v[176:191], a[192:195], v[128:131], v[176:191]
    v_cvt_pk_bf16_f32 v132, v136, v137
    v_cvt_pk_bf16_f32 v133, v138, v139
    v_cvt_pk_bf16_f32 v134, v140, v141
    v_cvt_pk_bf16_f32 v135, v142, v143
    v_rcp_f32 v160, v160
    v_mfma_f32_32x32x16_bf16 v[192:207], a[196:199], v[128:131], v[192:207]
    s_waitcnt lgkmcnt(2)
    buffer_store_dwordx4 v[72:75], v11, s[24:27], 0 offen offset:64 sc1 nt
    v_rcp_f32 v161, v161
    v_rcp_f32 v162, v162
    v_rcp_f32 v163, v163
    v_mfma_f32_32x32x16_bf16 v[208:223], a[200:203], v[128:131], v[208:223]
    v_rcp_f32 v164, v164
    v_rcp_f32 v165, v165
    v_rcp_f32 v166, v166
    v_mfma_f32_32x32x16_bf16 v[176:191], a[204:207], v[132:135], v[176:191]
    s_waitcnt lgkmcnt(1)
    buffer_store_dwordx4 v[76:79], v11, s[8:11], 0 offen offset:64 sc1 nt
    v_rcp_f32 v167, v167
    v_rcp_f32 v168, v168
    v_rcp_f32 v169, v169
    v_mfma_f32_32x32x16_bf16 v[192:207], a[208:211], v[132:135], v[192:207]
    v_rcp_f32 v170, v170
    v_rcp_f32 v171, v171
    v_rcp_f32 v172, v172
    v_mfma_f32_32x32x16_bf16 v[208:223], a[212:215], v[132:135], v[208:223]
    ds_write_b128 v0, v[84:87] offset:160
    v_rcp_f32 v173, v173
    v_rcp_f32 v174, v174
    v_rcp_f32 v175, v175
    v_add_u32_e64 v0, s47, v1
    v_pk_mul_f32 v[160:161], v[160:161], v[144:145]
    v_pk_mul_f32 v[162:163], v[162:163], v[146:147]
    v_pk_mul_f32 v[164:165], v[164:165], v[148:149]
    v_pk_mul_f32 v[166:167], v[166:167], v[150:151]
    v_pk_mul_f32 v[168:169], v[168:169], v[152:153]
    v_pk_mul_f32 v[170:171], v[170:171], v[154:155]
    v_pk_mul_f32 v[172:173], v[172:173], v[156:157]
    v_pk_mul_f32 v[174:175], v[174:175], v[158:159]
    v_pk_fma_f32 v[128:129], v[112:113], v[112:113], s[32:33]
    v_pk_fma_f32 v[130:131], v[114:115], v[114:115], s[32:33]
    v_pk_fma_f32 v[132:133], v[116:117], v[116:117], s[32:33]
    v_pk_fma_f32 v[134:135], v[118:119], v[118:119], s[32:33]
    v_pk_fma_f32 v[136:137], v[120:121], v[120:121], s[32:33]
    v_pk_fma_f32 v[138:139], v[122:123], v[122:123], s[32:33]
    v_pk_fma_f32 v[140:141], v[124:125], v[124:125], s[32:33]
    v_pk_fma_f32 v[142:143], v[126:127], v[126:127], s[32:33]
    v_pk_mul_f32 v[128:129], v[128:129], v[112:113] neg_lo:[1,0] neg_hi:[1,0]
    v_pk_mul_f32 v[130:131], v[130:131], v[114:115] neg_lo:[1,0] neg_hi:[1,0]
    v_pk_mul_f32 v[132:133], v[132:133], v[116:117] neg_lo:[1,0] neg_hi:[1,0]
    v_pk_mul_f32 v[134:135], v[134:135], v[118:119] neg_lo:[1,0] neg_hi:[1,0]
    v_pk_mul_f32 v[136:137], v[136:137], v[120:121] neg_lo:[1,0] neg_hi:[1,0]
    v_pk_mul_f32 v[138:139], v[138:139], v[122:123] neg_lo:[1,0] neg_hi:[1,0]
    v_pk_mul_f32 v[140:141], v[140:141], v[124:125] neg_lo:[1,0] neg_hi:[1,0]
    v_pk_mul_f32 v[142:143], v[142:143], v[126:127] neg_lo:[1,0] neg_hi:[1,0]
    v_mfma_f32_32x32x16_bf16 v[144:159], a[120:123], v[88:91], 0
    ds_read_b128 v[80:83], v9 offset:128
    ds_read_b128 v[84:87], v9 offset:3456
    v_exp_f32 v128, v128
    v_exp_f32 v129, v129
    v_mfma_f32_32x32x16_bf16 v[144:159], a[124:127], v[92:95], v[144:159]
    ds_read_b128 v[88:91], v0
    v_cvt_pk_bf16_f32 v160, v160, v161
    v_exp_f32 v130, v130
    v_exp_f32 v131, v131
    v_mfma_f32_32x32x16_bf16 v[144:159], a[128:131], v[96:99], v[144:159]
    ds_read_b128 v[92:95], v0 offset:1024
    v_cvt_pk_bf16_f32 v161, v162, v163
    v_exp_f32 v132, v132
    v_exp_f32 v133, v133
    v_mfma_f32_32x32x16_bf16 v[144:159], a[132:135], v[100:103], v[144:159]
    ds_read_b128 v[96:99], v0 offset:2048
    v_cvt_pk_bf16_f32 v162, v164, v165
    v_exp_f32 v134, v134
    v_exp_f32 v135, v135
    v_mfma_f32_32x32x16_bf16 v[144:159], a[136:139], v[104:107], v[144:159]
    v_exp_f32 v136, v136
    v_exp_f32 v137, v137
    v_exp_f32 v138, v138
    v_mfma_f32_32x32x16_bf16 v[144:159], a[140:143], v[108:111], v[144:159]
    v_cvt_pk_bf16_f32 v163, v166, v167
    v_exp_f32 v139, v139
    v_exp_f32 v140, v140
    v_exp_f32 v141, v141
    v_exp_f32 v142, v142
    v_exp_f32 v143, v143
    v_pk_fma_f32 v[128:129], v[128:129], s[34:35], s[34:35]
    v_pk_fma_f32 v[130:131], v[130:131], s[34:35], s[34:35]
    v_pk_fma_f32 v[132:133], v[132:133], s[34:35], s[34:35]
    v_pk_fma_f32 v[134:135], v[134:135], s[34:35], s[34:35]
    v_pk_fma_f32 v[136:137], v[136:137], s[34:35], s[34:35]
    v_pk_fma_f32 v[138:139], v[138:139], s[34:35], s[34:35]
    v_pk_fma_f32 v[140:141], v[140:141], s[34:35], s[34:35]
    v_pk_fma_f32 v[142:143], v[142:143], s[34:35], s[34:35]
    v_mfma_f32_32x32x16_bf16 v[176:191], a[216:219], v[160:163], v[176:191]
    ds_read_b128 v[100:103], v0 offset:3072
    v_cvt_pk_bf16_f32 v164, v168, v169
    v_cvt_pk_bf16_f32 v165, v170, v171
    v_cvt_pk_bf16_f32 v166, v172, v173
    v_cvt_pk_bf16_f32 v167, v174, v175
    v_rcp_f32 v128, v128
    v_mfma_f32_32x32x16_bf16 v[192:207], a[220:223], v[160:163], v[192:207]
    ds_read_b128 v[104:107], v0 offset:4096
    v_rcp_f32 v129, v129
    v_rcp_f32 v130, v130
    v_mfma_f32_32x32x16_bf16 v[208:223], a[224:227], v[160:163], v[208:223]
    ds_read_b128 v[108:111], v0 offset:5120
    v_rcp_f32 v131, v131
    v_rcp_f32 v132, v132
    v_rcp_f32 v133, v133
    v_mfma_f32_32x32x16_bf16 v[176:191], a[228:231], v[164:167], v[176:191]
    s_waitcnt lgkmcnt(7)
    buffer_store_dwordx4 v[80:83], v11, s[24:27], 0 offen offset:128 sc1 nt
    v_rcp_f32 v134, v134
    v_rcp_f32 v135, v135
    v_mfma_f32_32x32x16_bf16 v[192:207], a[232:235], v[164:167], v[192:207]
    v_rcp_f32 v136, v136
    v_rcp_f32 v137, v137
    v_rcp_f32 v138, v138
    v_mfma_f32_32x32x16_bf16 v[208:223], a[236:239], v[164:167], v[208:223]
    s_waitcnt lgkmcnt(6)
    buffer_store_dwordx4 v[84:87], v11, s[8:11], 0 offen offset:128 sc1 nt
    v_rcp_f32 v139, v139
    v_rcp_f32 v140, v140
    v_rcp_f32 v141, v141
    v_rcp_f32 v142, v142
    v_rcp_f32 v143, v143
    v_pk_mul_f32 v[128:129], v[128:129], v[112:113]
    v_pk_mul_f32 v[130:131], v[130:131], v[114:115]
    v_pk_mul_f32 v[132:133], v[132:133], v[116:117]
    v_pk_mul_f32 v[134:135], v[134:135], v[118:119]
    v_pk_mul_f32 v[136:137], v[136:137], v[120:121]
    v_pk_mul_f32 v[138:139], v[138:139], v[122:123]
    v_pk_mul_f32 v[140:141], v[140:141], v[124:125]
    v_pk_mul_f32 v[142:143], v[142:143], v[126:127]
    v_pk_fma_f32 v[160:161], v[144:145], v[144:145], s[32:33]
    v_pk_fma_f32 v[162:163], v[146:147], v[146:147], s[32:33]
    v_pk_fma_f32 v[164:165], v[148:149], v[148:149], s[32:33]
    v_pk_fma_f32 v[166:167], v[150:151], v[150:151], s[32:33]
    v_pk_fma_f32 v[168:169], v[152:153], v[152:153], s[32:33]
    v_pk_fma_f32 v[170:171], v[154:155], v[154:155], s[32:33]
    v_pk_fma_f32 v[172:173], v[156:157], v[156:157], s[32:33]
    v_pk_fma_f32 v[174:175], v[158:159], v[158:159], s[32:33]
    v_pk_mul_f32 v[160:161], v[160:161], v[144:145] neg_lo:[1,0] neg_hi:[1,0]
    v_pk_mul_f32 v[162:163], v[162:163], v[146:147] neg_lo:[1,0] neg_hi:[1,0]
    v_pk_mul_f32 v[164:165], v[164:165], v[148:149] neg_lo:[1,0] neg_hi:[1,0]
    v_pk_mul_f32 v[166:167], v[166:167], v[150:151] neg_lo:[1,0] neg_hi:[1,0]
    v_pk_mul_f32 v[168:169], v[168:169], v[152:153] neg_lo:[1,0] neg_hi:[1,0]
    v_pk_mul_f32 v[170:171], v[170:171], v[154:155] neg_lo:[1,0] neg_hi:[1,0]
    v_pk_mul_f32 v[172:173], v[172:173], v[156:157] neg_lo:[1,0] neg_hi:[1,0]
    v_pk_mul_f32 v[174:175], v[174:175], v[158:159] neg_lo:[1,0] neg_hi:[1,0]
    s_waitcnt lgkmcnt(0)
    v_mfma_f32_32x32x16_bf16 v[112:127], a[0:3], v[88:91], 0
    s_add_u32 s24, s24, s55
    v_exp_f32 v160, v160
    v_exp_f32 v161, v161
    v_exp_f32 v162, v162
    v_mfma_f32_32x32x16_bf16 v[112:127], a[4:7], v[92:95], v[112:127]
    s_addc_u32 s25, s25, s3
    v_exp_f32 v163, v163
    v_exp_f32 v164, v164
    v_exp_f32 v165, v165
    v_mfma_f32_32x32x16_bf16 v[112:127], a[8:11], v[96:99], v[112:127]
    s_add_u32 s8, s8, s55
    v_exp_f32 v166, v166
    v_exp_f32 v167, v167
    v_exp_f32 v168, v168
    v_mfma_f32_32x32x16_bf16 v[112:127], a[12:15], v[100:103], v[112:127]
    s_addc_u32 s9, s9, s3
    v_exp_f32 v169, v169
    v_exp_f32 v170, v170
    v_exp_f32 v171, v171
    v_mfma_f32_32x32x16_bf16 v[112:127], a[16:19], v[104:107], v[112:127]
    v_exp_f32 v172, v172
    v_exp_f32 v173, v173
    v_exp_f32 v174, v174
    v_mfma_f32_32x32x16_bf16 v[112:127], a[20:23], v[108:111], v[112:127]
    v_cvt_pk_bf16_f32 v128, v128, v129
    v_cvt_pk_bf16_f32 v129, v130, v131
    v_cvt_pk_bf16_f32 v130, v132, v133
    v_cvt_pk_bf16_f32 v131, v134, v135
    v_exp_f32 v175, v175
    v_add_u32 v9, s48, v1
    v_fma_f32 v160, v160, s34, s34
    v_fma_f32 v161, v161, s34, s34
    v_pk_fma_f32 v[162:163], v[162:163], s[34:35], s[34:35]
    v_pk_fma_f32 v[164:165], v[164:165], s[34:35], s[34:35]
    v_pk_fma_f32 v[166:167], v[166:167], s[34:35], s[34:35]
    v_pk_fma_f32 v[168:169], v[168:169], s[34:35], s[34:35]
    v_pk_fma_f32 v[170:171], v[170:171], s[34:35], s[34:35]
    v_pk_fma_f32 v[172:173], v[172:173], s[34:35], s[34:35]
    v_pk_fma_f32 v[174:175], v[174:175], s[34:35], s[34:35]
    v_mfma_f32_32x32x16_bf16 v[176:191], a[240:243], v[128:131], v[176:191]
    v_cvt_pk_bf16_f32 v132, v136, v137
    v_cvt_pk_bf16_f32 v133, v138, v139
    v_cvt_pk_bf16_f32 v134, v140, v141
    v_cvt_pk_bf16_f32 v135, v142, v143
    v_rcp_f32 v160, v160
    v_mfma_f32_32x32x16_bf16 v[192:207], a[244:247], v[128:131], v[192:207]
    s_mov_b32 s10, 0xc00
    v_rcp_f32 v161, v161
    v_rcp_f32 v162, v162
    v_rcp_f32 v163, v163
    v_mfma_f32_32x32x16_bf16 v[208:223], a[248:251], v[128:131], v[208:223]
    v_rcp_f32 v164, v164
    v_rcp_f32 v165, v165
    v_rcp_f32 v166, v166
    v_mfma_f32_32x32x16_bf16 v[176:191], a[252:255], v[132:135], v[176:191]
    v_rcp_f32 v167, v167
    v_rcp_f32 v168, v168
    v_rcp_f32 v169, v169
    v_mfma_f32_32x32x16_bf16 v[192:207], v[224:227], v[132:135], v[192:207]
    v_rcp_f32 v170, v170
    v_rcp_f32 v171, v171
    v_rcp_f32 v172, v172
    v_mfma_f32_32x32x16_bf16 v[208:223], v[228:231], v[132:135], v[208:223]
    v_rcp_f32 v173, v173
    v_rcp_f32 v174, v174
    v_rcp_f32 v175, v175
    v_mul_f32 v160, v160, v144
    v_mul_f32 v161, v161, v145
    v_mul_f32 v162, v162, v146
    v_mul_f32 v163, v163, v147
    v_pk_mul_f32 v[164:165], v[164:165], v[148:149]
    v_pk_mul_f32 v[166:167], v[166:167], v[150:151]
    v_pk_mul_f32 v[168:169], v[168:169], v[152:153]
    v_pk_mul_f32 v[170:171], v[170:171], v[154:155]
    v_pk_mul_f32 v[172:173], v[172:173], v[156:157]
    v_pk_mul_f32 v[174:175], v[174:175], v[158:159]
    v_pk_fma_f32 v[128:129], v[112:113], v[112:113], s[32:33]
    v_pk_fma_f32 v[130:131], v[114:115], v[114:115], s[32:33]
    v_pk_fma_f32 v[132:133], v[116:117], v[116:117], s[32:33]
    v_pk_fma_f32 v[134:135], v[118:119], v[118:119], s[32:33]
    v_pk_fma_f32 v[136:137], v[120:121], v[120:121], s[32:33]
    v_pk_fma_f32 v[138:139], v[122:123], v[122:123], s[32:33]
    v_pk_fma_f32 v[140:141], v[124:125], v[124:125], s[32:33]
    v_pk_fma_f32 v[142:143], v[126:127], v[126:127], s[32:33]
    v_pk_mul_f32 v[128:129], v[128:129], v[112:113] neg_lo:[1,0] neg_hi:[1,0]
    v_pk_mul_f32 v[130:131], v[130:131], v[114:115] neg_lo:[1,0] neg_hi:[1,0]
    v_pk_mul_f32 v[132:133], v[132:133], v[116:117] neg_lo:[1,0] neg_hi:[1,0]
    v_pk_mul_f32 v[134:135], v[134:135], v[118:119] neg_lo:[1,0] neg_hi:[1,0]
    v_pk_mul_f32 v[136:137], v[136:137], v[120:121] neg_lo:[1,0] neg_hi:[1,0]
    v_pk_mul_f32 v[138:139], v[138:139], v[122:123] neg_lo:[1,0] neg_hi:[1,0]
    v_pk_mul_f32 v[140:141], v[140:141], v[124:125] neg_lo:[1,0] neg_hi:[1,0]
    v_pk_mul_f32 v[142:143], v[142:143], v[126:127] neg_lo:[1,0] neg_hi:[1,0]
    v_cvt_pk_bf16_f32 v160, v160, v161
    v_cvt_pk_bf16_f32 v161, v162, v163
    v_cvt_pk_bf16_f32 v162, v164, v165
    v_cvt_pk_bf16_f32 v163, v166, v167
    v_exp_f32 v128, v128
    v_exp_f32 v129, v129
    v_mfma_f32_32x32x16_bf16 v[176:191], v[232:235], v[160:163], v[176:191]
    v_cvt_pk_bf16_f32 v164, v168, v169
    v_cvt_pk_bf16_f32 v165, v170, v171
    v_cvt_pk_bf16_f32 v166, v172, v173
    v_cvt_pk_bf16_f32 v167, v174, v175
    v_exp_f32 v130, v130
    s_nop 0
    v_mfma_f32_32x32x16_bf16 v[176:191], v[244:247], v[164:167], v[176:191]
    v_exp_f32 v131, v131
    v_exp_f32 v132, v132
    v_exp_f32 v133, v133
    v_mfma_f32_32x32x16_bf16 v[192:207], v[236:239], v[160:163], v[192:207]
    v_exp_f32 v134, v134
    v_exp_f32 v135, v135
    v_exp_f32 v136, v136
    v_mfma_f32_32x32x16_bf16 v[192:207], v[248:251], v[164:167], v[192:207]
    ds_write_b128 v9, v[176:179]
    v_add_u32 v10, s49, v1
    v_mfma_f32_32x32x16_bf16 v[208:223], v[240:243], v[160:163], v[208:223]
    v_exp_f32 v137, v137
    v_exp_f32 v138, v138
    v_exp_f32 v139, v139
    v_mfma_f32_32x32x16_bf16 v[208:223], v[252:255], v[164:167], v[208:223]
    ds_write_b128 v9, v[180:183] offset:1024
    v_exp_f32 v140, v140
    v_exp_f32 v141, v141
    v_exp_f32 v142, v142
    v_exp_f32 v143, v143
    v_pk_fma_f32 v[128:129], v[128:129], s[34:35], s[34:35]
    v_pk_fma_f32 v[130:131], v[130:131], s[34:35], s[34:35]
    v_pk_fma_f32 v[132:133], v[132:133], s[34:35], s[34:35]
    v_pk_fma_f32 v[134:135], v[134:135], s[34:35], s[34:35]
    ds_write_b128 v9, v[184:187] offset:2048
    v_pk_fma_f32 v[136:137], v[136:137], s[34:35], s[34:35]
    v_pk_fma_f32 v[138:139], v[138:139], s[34:35], s[34:35]
    v_pk_fma_f32 v[140:141], v[140:141], s[34:35], s[34:35]
    v_pk_fma_f32 v[142:143], v[142:143], s[34:35], s[34:35]
    v_mfma_f32_32x32x16_bf16 v[144:159], a[24:27], v[88:91], 0
    ds_write_b128 v9, v[188:191] offset:3072
    v_rcp_f32 v128, v128
    v_mfma_f32_32x32x16_bf16 v[144:159], a[28:31], v[92:95], v[144:159]
    v_rcp_f32 v129, v129
    v_rcp_f32 v130, v130
    v_rcp_f32 v131, v131
    v_mfma_f32_32x32x16_bf16 v[144:159], a[32:35], v[96:99], v[144:159]
    ds_write_b128 v9, v[192:195] offset:4096
    v_rcp_f32 v132, v132
    v_mfma_f32_32x32x16_bf16 v[144:159], a[36:39], v[100:103], v[144:159]
    v_rcp_f32 v133, v133
    v_rcp_f32 v134, v134
    v_rcp_f32 v135, v135
    v_mfma_f32_32x32x16_bf16 v[144:159], a[40:43], v[104:107], v[144:159]
    ds_write_b128 v9, v[196:199] offset:5120
    v_rcp_f32 v136, v136
    v_mfma_f32_32x32x16_bf16 v[144:159], a[44:47], v[108:111], v[144:159]
    s_mov_b32 s26, 0xc00
    v_rcp_f32 v137, v137
    v_rcp_f32 v138, v138
    v_rcp_f32 v139, v139
    v_rcp_f32 v140, v140
    ds_write_b128 v9, v[200:203] offset:6144
    v_rcp_f32 v141, v141
    v_rcp_f32 v142, v142
    v_rcp_f32 v143, v143
    v_pk_mul_f32 v[128:129], v[128:129], v[112:113]
    v_pk_mul_f32 v[130:131], v[130:131], v[114:115]
    v_pk_mul_f32 v[132:133], v[132:133], v[116:117]
    v_pk_mul_f32 v[134:135], v[134:135], v[118:119]
    v_pk_mul_f32 v[136:137], v[136:137], v[120:121]
    v_pk_mul_f32 v[138:139], v[138:139], v[122:123]
    ds_write_b128 v9, v[204:207] offset:7168
    v_pk_mul_f32 v[140:141], v[140:141], v[124:125]
    v_pk_mul_f32 v[142:143], v[142:143], v[126:127]
    v_pk_fma_f32 v[160:161], v[144:145], v[144:145], s[32:33]
    v_pk_fma_f32 v[162:163], v[146:147], v[146:147], s[32:33]
    v_pk_fma_f32 v[164:165], v[148:149], v[148:149], s[32:33]
    v_pk_fma_f32 v[166:167], v[150:151], v[150:151], s[32:33]
    v_pk_fma_f32 v[168:169], v[152:153], v[152:153], s[32:33]
    v_pk_fma_f32 v[170:171], v[154:155], v[154:155], s[32:33]
    v_pk_fma_f32 v[172:173], v[156:157], v[156:157], s[32:33]
    v_pk_fma_f32 v[174:175], v[158:159], v[158:159], s[32:33]
    v_pk_mul_f32 v[160:161], v[160:161], v[144:145] neg_lo:[1,0] neg_hi:[1,0]
    v_pk_mul_f32 v[162:163], v[162:163], v[146:147] neg_lo:[1,0] neg_hi:[1,0]
    ds_write_b128 v9, v[208:211] offset:8192
    v_pk_mul_f32 v[164:165], v[164:165], v[148:149] neg_lo:[1,0] neg_hi:[1,0]
    v_pk_mul_f32 v[166:167], v[166:167], v[150:151] neg_lo:[1,0] neg_hi:[1,0]
    v_pk_mul_f32 v[168:169], v[168:169], v[152:153] neg_lo:[1,0] neg_hi:[1,0]
    v_pk_mul_f32 v[170:171], v[170:171], v[154:155] neg_lo:[1,0] neg_hi:[1,0]
    v_pk_mul_f32 v[172:173], v[172:173], v[156:157] neg_lo:[1,0] neg_hi:[1,0]
    v_pk_mul_f32 v[174:175], v[174:175], v[158:159] neg_lo:[1,0] neg_hi:[1,0]
    v_mfma_f32_32x32x16_bf16 v[112:127], a[48:51], v[88:91], 0
    ds_write_b128 v9, v[212:215] offset:9216
    v_cvt_pk_bf16_f32 v128, v128, v129
    v_mfma_f32_32x32x16_bf16 v[112:127], a[52:55], v[92:95], v[112:127]
    ds_write_b128 v9, v[216:219] offset:10240
    v_cvt_pk_bf16_f32 v129, v130, v131
    v_mfma_f32_32x32x16_bf16 v[112:127], a[56:59], v[96:99], v[112:127]
    ds_write_b128 v9, v[220:223] offset:11264
    v_cvt_pk_bf16_f32 v130, v132, v133
    v_mfma_f32_32x32x16_bf16 v[112:127], a[60:63], v[100:103], v[112:127]
    v_exp_f32 v160, v160
    v_exp_f32 v161, v161
    v_exp_f32_e64 v162, v162
    v_mfma_f32_32x32x16_bf16 v[112:127], a[64:67], v[104:107], v[112:127]
    s_waitcnt lgkmcnt(0)
    s_barrier
    ds_read_b128 v[176:179], v10
    ds_read_b128 v[180:183], v10 offset:1024
    v_mfma_f32_32x32x16_bf16 v[112:127], a[68:71], v[108:111], v[112:127]
    ds_read_b128 v[184:187], v10 offset:2048
    ds_read_b128 v[188:191], v10 offset:3072
    v_cvt_pk_bf16_f32 v131, v134, v135
    v_cvt_pk_bf16_f32 v132, v136, v137
    v_cvt_pk_bf16_f32 v133, v138, v139
    v_cvt_pk_bf16_f32 v134, v140, v141
    v_cvt_pk_bf16_f32 v135, v142, v143
    v_exp_f32 v163, v163
    v_exp_f32 v164, v164
    v_exp_f32 v165, v165
    v_exp_f32 v166, v166
    v_exp_f32 v167, v167
    v_exp_f32 v168, v168
    v_exp_f32 v169, v169
    ds_read_b128 v[192:195], v10 offset:4096
    ds_read_b128 v[196:199], v10 offset:5120
    v_exp_f32 v170, v170
    v_exp_f32 v171, v171
    v_exp_f32 v172, v172
    ds_read_b128 v[200:203], v10 offset:6144
    ds_read_b128 v[204:207], v10 offset:7168
    v_exp_f32 v173, v173
    v_exp_f32 v174, v174
    v_exp_f32_e64 v175, v175
    v_pk_fma_f32 v[160:161], v[160:161], s[34:35], s[34:35]
    v_pk_fma_f32 v[162:163], v[162:163], s[34:35], s[34:35]
    v_pk_fma_f32 v[164:165], v[164:165], s[34:35], s[34:35]
    v_pk_fma_f32 v[166:167], v[166:167], s[34:35], s[34:35]
    v_pk_fma_f32 v[168:169], v[168:169], s[34:35], s[34:35]
    v_pk_fma_f32 v[170:171], v[170:171], s[34:35], s[34:35]
    v_pk_fma_f32 v[172:173], v[172:173], s[34:35], s[34:35]
    v_pk_fma_f32 v[174:175], v[174:175], s[34:35], s[34:35]
    s_waitcnt lgkmcnt(0)
    v_mfma_f32_32x32x16_bf16 v[176:191], a[144:147], v[128:131], v[176:191]
    ds_read_b128 v[208:211], v10 offset:8192
    ds_read_b128 v[212:215], v10 offset:9216
    v_rcp_f32 v160, v160
    v_rcp_f32_e64 v161, v161
    v_mfma_f32_32x32x16_bf16 v[176:191], a[156:159], v[132:135], v[176:191]
    ds_read_b128 v[216:219], v10 offset:10240
    ds_read_b128 v[220:223], v10 offset:11264
    v_rcp_f32 v162, v162
    v_rcp_f32 v163, v163
    v_mfma_f32_32x32x16_bf16 v[192:207], a[148:151], v[128:131], v[192:207]
    v_rcp_f32 v164, v164
    v_rcp_f32 v165, v165
    v_rcp_f32 v166, v166
    v_mfma_f32_32x32x16_bf16 v[192:207], a[160:163], v[132:135], v[192:207]
    s_waitcnt lgkmcnt(0)
    v_rcp_f32 v167, v167
    v_rcp_f32 v168, v168
    v_rcp_f32 v169, v169
    v_mfma_f32_32x32x16_bf16 v[208:223], a[152:155], v[128:131], v[208:223]
    v_rcp_f32 v170, v170
    v_rcp_f32 v171, v171
    v_rcp_f32 v172, v172
    v_mfma_f32_32x32x16_bf16 v[208:223], a[164:167], v[132:135], v[208:223]
    v_rcp_f32 v173, v173
    v_rcp_f32 v174, v174
    v_rcp_f32 v175, v175
    v_mul_f32 v160, v160, v144
    v_mul_f32 v161, v161, v145
    v_mul_f32 v162, v162, v146
    v_mul_f32_e64 v163, v163, v147
    v_pk_mul_f32 v[164:165], v[164:165], v[148:149]
    v_pk_mul_f32 v[166:167], v[166:167], v[150:151]
    v_pk_mul_f32 v[168:169], v[168:169], v[152:153]
    v_pk_mul_f32 v[170:171], v[170:171], v[154:155]
    v_pk_mul_f32 v[172:173], v[172:173], v[156:157]
    v_pk_mul_f32 v[174:175], v[174:175], v[158:159]
    v_pk_fma_f32 v[128:129], v[112:113], v[112:113], s[32:33]
    v_pk_fma_f32 v[130:131], v[114:115], v[114:115], s[32:33]
    v_pk_fma_f32 v[132:133], v[116:117], v[116:117], s[32:33]
    v_pk_fma_f32 v[134:135], v[118:119], v[118:119], s[32:33]
    v_pk_fma_f32 v[136:137], v[120:121], v[120:121], s[32:33]
    v_pk_fma_f32 v[138:139], v[122:123], v[122:123], s[32:33]
    v_pk_fma_f32 v[140:141], v[124:125], v[124:125], s[32:33]
    v_pk_fma_f32 v[142:143], v[126:127], v[126:127], s[32:33]
    v_pk_mul_f32 v[128:129], v[128:129], v[112:113] neg_lo:[1,0] neg_hi:[1,0]
    v_pk_mul_f32 v[130:131], v[130:131], v[114:115] neg_lo:[1,0] neg_hi:[1,0]
    v_pk_mul_f32 v[132:133], v[132:133], v[116:117] neg_lo:[1,0] neg_hi:[1,0]
    v_pk_mul_f32 v[134:135], v[134:135], v[118:119] neg_lo:[1,0] neg_hi:[1,0]
    v_pk_mul_f32 v[136:137], v[136:137], v[120:121] neg_lo:[1,0] neg_hi:[1,0]
    v_pk_mul_f32 v[138:139], v[138:139], v[122:123] neg_lo:[1,0] neg_hi:[1,0]
    v_pk_mul_f32 v[140:141], v[140:141], v[124:125] neg_lo:[1,0] neg_hi:[1,0]
    v_pk_mul_f32 v[142:143], v[142:143], v[126:127] neg_lo:[1,0] neg_hi:[1,0]
    v_mfma_f32_32x32x16_bf16 v[144:159], a[72:75], v[88:91], 0
    v_exp_f32 v128, v128
    v_exp_f32 v129, v129
    v_exp_f32 v130, v130
    v_mfma_f32_32x32x16_bf16 v[144:159], a[76:79], v[92:95], v[144:159]
    v_exp_f32 v131, v131
    v_exp_f32 v132, v132
    v_exp_f32 v133, v133
    v_mfma_f32_32x32x16_bf16 v[144:159], a[80:83], v[96:99], v[144:159]
    v_exp_f32 v134, v134
    v_exp_f32 v135, v135
    v_exp_f32 v136, v136
    v_mfma_f32_32x32x16_bf16 v[144:159], a[84:87], v[100:103], v[144:159]
    v_exp_f32 v137, v137
    v_exp_f32 v138, v138
    v_exp_f32 v139, v139
    v_mfma_f32_32x32x16_bf16 v[144:159], a[88:91], v[104:107], v[144:159]
    v_exp_f32 v140, v140
    v_exp_f32 v141, v141
    v_exp_f32_e64 v142, v142
    v_mfma_f32_32x32x16_bf16 v[144:159], a[92:95], v[108:111], v[144:159]
    v_cvt_pk_bf16_f32 v160, v160, v161
    v_cvt_pk_bf16_f32 v161, v162, v163
    v_cvt_pk_bf16_f32 v162, v164, v165
    v_cvt_pk_bf16_f32 v163, v166, v167
    v_exp_f32_e64 v143, v143
    v_fma_f32 v128, v128, s34, s34
    v_fma_f32 v129, v129, s34, s34
    v_fma_f32 v130, v130, s34, s34
    v_fma_f32 v131, v131, s34, s34
    v_pk_fma_f32 v[132:133], v[132:133], s[34:35], s[34:35]
    v_pk_fma_f32 v[134:135], v[134:135], s[34:35], s[34:35]
    v_pk_fma_f32 v[136:137], v[136:137], s[34:35], s[34:35]
    v_pk_fma_f32 v[138:139], v[138:139], s[34:35], s[34:35]
    v_pk_fma_f32 v[140:141], v[140:141], s[34:35], s[34:35]
    v_pk_fma_f32 v[142:143], v[142:143], s[34:35], s[34:35]
    v_mfma_f32_32x32x16_bf16 v[176:191], a[168:171], v[160:163], v[176:191]
    v_cvt_pk_bf16_f32 v164, v168, v169
    v_cvt_pk_bf16_f32 v165, v170, v171
    v_cvt_pk_bf16_f32 v166, v172, v173
    v_cvt_pk_bf16_f32 v167, v174, v175
    v_rcp_f32 v128, v128
    v_mfma_f32_32x32x16_bf16 v[192:207], a[172:175], v[160:163], v[192:207]
    v_rcp_f32 v129, v129
    v_rcp_f32 v130, v130
    v_rcp_f32 v131, v131
    v_mfma_f32_32x32x16_bf16 v[208:223], a[176:179], v[160:163], v[208:223]
    v_rcp_f32 v132, v132
    v_rcp_f32 v133, v133
    v_rcp_f32 v134, v134
    v_mfma_f32_32x32x16_bf16 v[176:191], a[180:183], v[164:167], v[176:191]
    v_rcp_f32 v135, v135
    v_rcp_f32 v136, v136
    v_rcp_f32 v137, v137
    v_mfma_f32_32x32x16_bf16 v[192:207], a[184:187], v[164:167], v[192:207]
    v_rcp_f32 v138, v138
    v_rcp_f32 v139, v139
    v_rcp_f32 v140, v140
    v_mfma_f32_32x32x16_bf16 v[208:223], a[188:191], v[164:167], v[208:223]
    v_rcp_f32 v141, v141
    v_rcp_f32 v142, v142
    v_rcp_f32 v143, v143
    v_mul_f32 v128, v128, v112
    v_mul_f32 v129, v129, v113
    v_mul_f32 v130, v130, v114
    v_mul_f32 v131, v131, v115
    v_pk_mul_f32 v[132:133], v[132:133], v[116:117]
    v_pk_mul_f32 v[134:135], v[134:135], v[118:119]
    v_pk_mul_f32 v[136:137], v[136:137], v[120:121]
    v_pk_mul_f32 v[138:139], v[138:139], v[122:123]
    v_pk_mul_f32 v[140:141], v[140:141], v[124:125]
    v_pk_mul_f32 v[142:143], v[142:143], v[126:127]
    v_pk_fma_f32 v[160:161], v[144:145], v[144:145], s[32:33]
    v_pk_fma_f32 v[162:163], v[146:147], v[146:147], s[32:33]
    v_pk_fma_f32 v[164:165], v[148:149], v[148:149], s[32:33]
    v_pk_fma_f32 v[166:167], v[150:151], v[150:151], s[32:33]
    v_pk_fma_f32 v[168:169], v[152:153], v[152:153], s[32:33]
    v_pk_fma_f32 v[170:171], v[154:155], v[154:155], s[32:33]
    v_pk_fma_f32 v[172:173], v[156:157], v[156:157], s[32:33]
    v_pk_fma_f32 v[174:175], v[158:159], v[158:159], s[32:33]
    v_pk_mul_f32 v[160:161], v[160:161], v[144:145] neg_lo:[1,0] neg_hi:[1,0]
    v_pk_mul_f32 v[162:163], v[162:163], v[146:147] neg_lo:[1,0] neg_hi:[1,0]
    v_pk_mul_f32 v[164:165], v[164:165], v[148:149] neg_lo:[1,0] neg_hi:[1,0]
    v_pk_mul_f32 v[166:167], v[166:167], v[150:151] neg_lo:[1,0] neg_hi:[1,0]
    v_pk_mul_f32 v[168:169], v[168:169], v[152:153] neg_lo:[1,0] neg_hi:[1,0]
    v_pk_mul_f32 v[170:171], v[170:171], v[154:155] neg_lo:[1,0] neg_hi:[1,0]
    v_pk_mul_f32 v[172:173], v[172:173], v[156:157] neg_lo:[1,0] neg_hi:[1,0]
    v_pk_mul_f32 v[174:175], v[174:175], v[158:159] neg_lo:[1,0] neg_hi:[1,0]
    v_mfma_f32_32x32x16_bf16 v[112:127], a[96:99], v[88:91], 0
    v_exp_f32 v160, v160
    v_exp_f32 v161, v161
    v_exp_f32 v162, v162
    v_mfma_f32_32x32x16_bf16 v[112:127], a[100:103], v[92:95], v[112:127]
    v_exp_f32 v163, v163
    v_exp_f32 v164, v164
    v_exp_f32 v165, v165
    v_mfma_f32_32x32x16_bf16 v[112:127], a[104:107], v[96:99], v[112:127]
    v_exp_f32 v166, v166
    v_exp_f32 v167, v167
    v_exp_f32 v168, v168
    v_mfma_f32_32x32x16_bf16 v[112:127], a[108:111], v[100:103], v[112:127]
    v_exp_f32 v169, v169
    v_exp_f32 v170, v170
    v_exp_f32 v171, v171
    v_mfma_f32_32x32x16_bf16 v[112:127], a[112:115], v[104:107], v[112:127]
    v_exp_f32 v172, v172
    v_exp_f32 v173, v173
    v_exp_f32_e64 v174, v174
    v_mfma_f32_32x32x16_bf16 v[112:127], a[116:119], v[108:111], v[112:127]
    v_cvt_pk_bf16_f32 v128, v128, v129
    v_cvt_pk_bf16_f32 v129, v130, v131
    v_cvt_pk_bf16_f32 v130, v132, v133
    v_cvt_pk_bf16_f32 v131, v134, v135
    v_exp_f32_e64 v175, v175
    v_fma_f32 v160, v160, s34, s34
    v_fma_f32 v161, v161, s34, s34
    v_fma_f32 v162, v162, s34, s34
    v_fma_f32 v163, v163, s34, s34
    v_pk_fma_f32 v[164:165], v[164:165], s[34:35], s[34:35]
    v_pk_fma_f32 v[166:167], v[166:167], s[34:35], s[34:35]
    v_pk_fma_f32 v[168:169], v[168:169], s[34:35], s[34:35]
    v_pk_fma_f32 v[170:171], v[170:171], s[34:35], s[34:35]
    v_pk_fma_f32 v[172:173], v[172:173], s[34:35], s[34:35]
    v_pk_fma_f32 v[174:175], v[174:175], s[34:35], s[34:35]
    v_mfma_f32_32x32x16_bf16 v[176:191], a[192:195], v[128:131], v[176:191]
    v_cvt_pk_bf16_f32 v132, v136, v137
    v_cvt_pk_bf16_f32 v133, v138, v139
    v_cvt_pk_bf16_f32 v134, v140, v141
    v_cvt_pk_bf16_f32 v135, v142, v143
    v_rcp_f32 v160, v160
    v_mfma_f32_32x32x16_bf16 v[192:207], a[196:199], v[128:131], v[192:207]
    v_rcp_f32 v161, v161
    v_rcp_f32 v162, v162
    v_rcp_f32 v163, v163
    v_mfma_f32_32x32x16_bf16 v[208:223], a[200:203], v[128:131], v[208:223]
    v_rcp_f32 v164, v164
    v_rcp_f32 v165, v165
    v_rcp_f32 v166, v166
    v_mfma_f32_32x32x16_bf16 v[176:191], a[204:207], v[132:135], v[176:191]
    v_rcp_f32 v167, v167
    v_rcp_f32 v168, v168
    v_rcp_f32 v169, v169
    v_mfma_f32_32x32x16_bf16 v[192:207], a[208:211], v[132:135], v[192:207]
    v_rcp_f32 v170, v170
    v_rcp_f32 v171, v171
    v_rcp_f32 v172, v172
    v_mfma_f32_32x32x16_bf16 v[208:223], a[212:215], v[132:135], v[208:223]
    buffer_load_dwordx4 v[12:15], v8, s[20:23], 0 offen
    v_rcp_f32 v173, v173
    v_rcp_f32 v174, v174
    v_rcp_f32 v175, v175
    v_mul_f32 v160, v160, v144
    v_mul_f32 v161, v161, v145
    v_pk_mul_f32 v[162:163], v[162:163], v[146:147]
    v_pk_mul_f32 v[164:165], v[164:165], v[148:149]
    v_pk_mul_f32 v[166:167], v[166:167], v[150:151]
    v_pk_mul_f32 v[168:169], v[168:169], v[152:153]
    v_pk_mul_f32 v[170:171], v[170:171], v[154:155]
    v_pk_mul_f32 v[172:173], v[172:173], v[156:157]
    v_pk_mul_f32 v[174:175], v[174:175], v[158:159]
    v_pk_fma_f32 v[128:129], v[112:113], v[112:113], s[32:33]
    v_pk_fma_f32 v[130:131], v[114:115], v[114:115], s[32:33]
    v_pk_fma_f32 v[132:133], v[116:117], v[116:117], s[32:33]
    v_pk_fma_f32 v[134:135], v[118:119], v[118:119], s[32:33]
    v_pk_fma_f32 v[136:137], v[120:121], v[120:121], s[32:33]
    v_pk_fma_f32 v[138:139], v[122:123], v[122:123], s[32:33]
    v_pk_fma_f32 v[140:141], v[124:125], v[124:125], s[32:33]
    v_pk_fma_f32 v[142:143], v[126:127], v[126:127], s[32:33]
    v_pk_mul_f32 v[128:129], v[128:129], v[112:113] neg_lo:[1,0] neg_hi:[1,0]
    v_pk_mul_f32 v[130:131], v[130:131], v[114:115] neg_lo:[1,0] neg_hi:[1,0]
    v_pk_mul_f32 v[132:133], v[132:133], v[116:117] neg_lo:[1,0] neg_hi:[1,0]
    v_pk_mul_f32 v[134:135], v[134:135], v[118:119] neg_lo:[1,0] neg_hi:[1,0]
    v_pk_mul_f32 v[136:137], v[136:137], v[120:121] neg_lo:[1,0] neg_hi:[1,0]
    v_pk_mul_f32 v[138:139], v[138:139], v[122:123] neg_lo:[1,0] neg_hi:[1,0]
    v_pk_mul_f32 v[140:141], v[140:141], v[124:125] neg_lo:[1,0] neg_hi:[1,0]
    v_pk_mul_f32 v[142:143], v[142:143], v[126:127] neg_lo:[1,0] neg_hi:[1,0]
    v_mfma_f32_32x32x16_bf16 v[144:159], a[120:123], v[88:91], 0
    buffer_load_dwordx4 v[16:19], v8, s[20:23], 0 offen offset:32
    v_cvt_pk_bf16_f32 v160, v160, v161
    v_exp_f32 v128, v128
    v_exp_f32 v129, v129
    v_mfma_f32_32x32x16_bf16 v[144:159], a[124:127], v[92:95], v[144:159]
    v_exp_f32 v130, v130
    v_exp_f32 v131, v131
    v_exp_f32 v132, v132
    v_mfma_f32_32x32x16_bf16 v[144:159], a[128:131], v[96:99], v[144:159]
    v_exp_f32 v133, v133
    v_exp_f32 v134, v134
    v_exp_f32 v135, v135
    v_mfma_f32_32x32x16_bf16 v[144:159], a[132:135], v[100:103], v[144:159]
    v_exp_f32 v136, v136
    v_exp_f32 v137, v137
    v_exp_f32_e64 v138, v138
    v_mfma_f32_32x32x16_bf16 v[144:159], a[136:139], v[104:107], v[144:159]
    buffer_load_dwordx4 v[20:23], v8, s[20:23], 0 offen offset:64
    v_cvt_pk_bf16_f32 v161, v162, v163
    v_exp_f32 v139, v139
    v_exp_f32 v140, v140
    v_mfma_f32_32x32x16_bf16 v[144:159], a[140:143], v[108:111], v[144:159]
    v_cvt_pk_bf16_f32 v162, v164, v165
    v_cvt_pk_bf16_f32 v163, v166, v167
    v_exp_f32 v141, v141
    v_exp_f32 v142, v142
    v_exp_f32_e64 v143, v143
    v_fma_f32 v128, v128, s34, s34
    v_fma_f32 v129, v129, s34, s34
    v_pk_fma_f32 v[130:131], v[130:131], s[34:35], s[34:35]
    v_pk_fma_f32 v[132:133], v[132:133], s[34:35], s[34:35]
    v_pk_fma_f32 v[134:135], v[134:135], s[34:35], s[34:35]
    v_pk_fma_f32 v[136:137], v[136:137], s[34:35], s[34:35]
    v_pk_fma_f32 v[138:139], v[138:139], s[34:35], s[34:35]
    v_pk_fma_f32 v[140:141], v[140:141], s[34:35], s[34:35]
    v_pk_fma_f32 v[142:143], v[142:143], s[34:35], s[34:35]
    v_mfma_f32_32x32x16_bf16 v[176:191], a[216:219], v[160:163], v[176:191]
    v_cvt_pk_bf16_f32 v164, v168, v169
    v_cvt_pk_bf16_f32 v165, v170, v171
    v_cvt_pk_bf16_f32 v166, v172, v173
    v_cvt_pk_bf16_f32 v167, v174, v175
    v_rcp_f32 v128, v128
    v_mfma_f32_32x32x16_bf16 v[192:207], a[220:223], v[160:163], v[192:207]
    v_rcp_f32 v129, v129
    v_rcp_f32 v130, v130
    v_rcp_f32 v131, v131
    v_mfma_f32_32x32x16_bf16 v[208:223], a[224:227], v[160:163], v[208:223]
    v_rcp_f32 v132, v132
    v_rcp_f32 v133, v133
    v_rcp_f32 v134, v134
    v_mfma_f32_32x32x16_bf16 v[176:191], a[228:231], v[164:167], v[176:191]
    v_rcp_f32 v135, v135
    v_rcp_f32 v136, v136
    v_rcp_f32 v137, v137
    v_mfma_f32_32x32x16_bf16 v[192:207], a[232:235], v[164:167], v[192:207]
    buffer_load_dwordx4 v[24:27], v8, s[20:23], 0 offen offset:96
    v_rcp_f32 v138, v138
    v_rcp_f32 v139, v139
    v_mfma_f32_32x32x16_bf16 v[208:223], a[236:239], v[164:167], v[208:223]
    v_rcp_f32 v140, v140
    v_rcp_f32 v141, v141
    v_rcp_f32 v142, v142
    v_rcp_f32 v143, v143
    v_mul_f32 v128, v128, v112
    v_mul_f32 v129, v129, v113
    v_pk_mul_f32 v[130:131], v[130:131], v[114:115]
    v_pk_mul_f32 v[132:133], v[132:133], v[116:117]
    v_pk_mul_f32 v[134:135], v[134:135], v[118:119]
    v_pk_mul_f32 v[136:137], v[136:137], v[120:121]
    v_pk_mul_f32 v[138:139], v[138:139], v[122:123]
    v_pk_mul_f32 v[140:141], v[140:141], v[124:125]
    v_pk_mul_f32 v[142:143], v[142:143], v[126:127]
    v_pk_fma_f32 v[160:161], v[144:145], v[144:145], s[32:33]
    v_pk_fma_f32 v[162:163], v[146:147], v[146:147], s[32:33]
    v_pk_fma_f32 v[164:165], v[148:149], v[148:149], s[32:33]
    v_pk_fma_f32 v[166:167], v[150:151], v[150:151], s[32:33]
    v_pk_fma_f32 v[168:169], v[152:153], v[152:153], s[32:33]
    v_pk_fma_f32 v[170:171], v[154:155], v[154:155], s[32:33]
    v_pk_fma_f32 v[172:173], v[156:157], v[156:157], s[32:33]
    v_pk_fma_f32 v[174:175], v[158:159], v[158:159], s[32:33]
    v_pk_mul_f32 v[160:161], v[160:161], v[144:145] neg_lo:[1,0] neg_hi:[1,0]
    v_pk_mul_f32 v[162:163], v[162:163], v[146:147] neg_lo:[1,0] neg_hi:[1,0]
    v_pk_mul_f32 v[164:165], v[164:165], v[148:149] neg_lo:[1,0] neg_hi:[1,0]
    v_pk_mul_f32 v[166:167], v[166:167], v[150:151] neg_lo:[1,0] neg_hi:[1,0]
    v_pk_mul_f32 v[168:169], v[168:169], v[152:153] neg_lo:[1,0] neg_hi:[1,0]
    v_pk_mul_f32 v[170:171], v[170:171], v[154:155] neg_lo:[1,0] neg_hi:[1,0]
    v_pk_mul_f32 v[172:173], v[172:173], v[156:157] neg_lo:[1,0] neg_hi:[1,0]
    v_pk_mul_f32 v[174:175], v[174:175], v[158:159] neg_lo:[1,0] neg_hi:[1,0]
    buffer_load_dwordx4 v[28:31], v8, s[20:23], 0 offen offset:128
    buffer_load_dwordx4 v[32:35], v8, s[20:23], 0 offen offset:160
    v_cvt_pk_bf16_f32 v128, v128, v129
    v_cvt_pk_bf16_f32 v129, v130, v131
    v_cvt_pk_bf16_f32 v130, v132, v133
    v_cvt_pk_bf16_f32 v131, v134, v135
    v_exp_f32 v160, v160
    v_exp_f32 v161, v161
    v_exp_f32 v162, v162
    v_exp_f32 v163, v163
    v_exp_f32 v164, v164
    v_exp_f32 v165, v165
    v_exp_f32 v166, v166
    v_exp_f32 v167, v167
    v_exp_f32 v168, v168
    v_exp_f32 v169, v169
    v_exp_f32 v170, v170
    v_exp_f32 v171, v171
    v_exp_f32 v172, v172
    v_exp_f32 v173, v173
    v_exp_f32 v174, v174
    v_exp_f32_e64 v175, v175
    v_pk_fma_f32 v[160:161], v[160:161], s[34:35], s[34:35]
    v_pk_fma_f32 v[162:163], v[162:163], s[34:35], s[34:35]
    v_pk_fma_f32 v[164:165], v[164:165], s[34:35], s[34:35]
    v_pk_fma_f32 v[166:167], v[166:167], s[34:35], s[34:35]
    v_pk_fma_f32 v[168:169], v[168:169], s[34:35], s[34:35]
    v_pk_fma_f32 v[170:171], v[170:171], s[34:35], s[34:35]
    v_pk_fma_f32 v[172:173], v[172:173], s[34:35], s[34:35]
    v_pk_fma_f32 v[174:175], v[174:175], s[34:35], s[34:35]
    s_waitcnt vmcnt(5)
    v_dot2_f32_bf16 v176, v12, s51, v176
    v_dot2_f32_bf16 v177, v12, s52, v177
    v_dot2_f32_bf16 v178, v13, s51, v178
    v_dot2_f32_bf16 v179, v13, s52, v179
    v_dot2_f32_bf16 v180, v14, s51, v180
    v_dot2_f32_bf16 v181, v14, s52, v181
    v_dot2_f32_bf16 v182, v15, s51, v182
    v_dot2_f32_bf16 v183, v15, s52, v183
    s_waitcnt vmcnt(4)
    v_dot2_f32_bf16 v184, v16, s51, v184
    v_dot2_f32_bf16 v185, v16, s52, v185
    v_dot2_f32_bf16 v186, v17, s51, v186
    v_dot2_f32_bf16 v187, v17, s52, v187
    v_dot2_f32_bf16 v188, v18, s51, v188
    v_dot2_f32_bf16 v189, v18, s52, v189
    v_dot2_f32_bf16 v190, v19, s51, v190
    v_dot2_f32_bf16 v191, v19, s52, v191
    s_waitcnt vmcnt(3)
    v_dot2_f32_bf16 v192, v20, s51, v192
    v_dot2_f32_bf16 v193, v20, s52, v193
    v_dot2_f32_bf16 v194, v21, s51, v194
    v_dot2_f32_bf16 v195, v21, s52, v195
    v_dot2_f32_bf16 v196, v22, s51, v196
    v_dot2_f32_bf16 v197, v22, s52, v197
    v_dot2_f32_bf16 v198, v23, s51, v198
    v_dot2_f32_bf16 v199, v23, s52, v199
    v_mfma_f32_32x32x16_bf16 v[176:191], a[240:243], v[128:131], v[176:191]
    v_cvt_pk_bf16_f32 v132, v136, v137
    v_cvt_pk_bf16_f32 v133, v138, v139
    v_cvt_pk_bf16_f32 v134, v140, v141
    v_cvt_pk_bf16_f32 v135, v142, v143
    v_rcp_f32 v160, v160
    v_mfma_f32_32x32x16_bf16 v[192:207], a[244:247], v[128:131], v[192:207]
    v_rcp_f32 v161, v161
    v_rcp_f32 v162, v162
    v_rcp_f32 v163, v163
    v_mfma_f32_32x32x16_bf16 v[208:223], a[248:251], v[128:131], v[208:223]
    v_rcp_f32 v164, v164
    v_rcp_f32 v165, v165
    v_rcp_f32 v166, v166
    v_mfma_f32_32x32x16_bf16 v[176:191], a[252:255], v[132:135], v[176:191]
    v_rcp_f32 v167, v167
    v_rcp_f32 v168, v168
    v_rcp_f32 v169, v169
    v_mfma_f32_32x32x16_bf16 v[192:207], v[224:227], v[132:135], v[192:207]
    v_rcp_f32 v170, v170
    v_rcp_f32 v171, v171
    v_rcp_f32 v172, v172
    v_mfma_f32_32x32x16_bf16 v[208:223], v[228:231], v[132:135], v[208:223]
    s_waitcnt vmcnt(0)
    v_rcp_f32 v173, v173
    v_rcp_f32 v174, v174
    v_rcp_f32 v175, v175
    v_mul_f32 v160, v160, v144
    v_mul_f32 v161, v161, v145
    v_mul_f32 v162, v162, v146
    v_mul_f32_e64 v163, v163, v147
    v_pk_mul_f32 v[164:165], v[164:165], v[148:149]
    v_pk_mul_f32 v[166:167], v[166:167], v[150:151]
    v_pk_mul_f32 v[168:169], v[168:169], v[152:153]
    v_pk_mul_f32 v[170:171], v[170:171], v[154:155]
    v_pk_mul_f32 v[172:173], v[172:173], v[156:157]
    v_pk_mul_f32 v[174:175], v[174:175], v[158:159]
    v_dot2_f32_bf16 v200, v24, s51, v200
    v_dot2_f32_bf16 v201, v24, s52, v201
    v_dot2_f32_bf16 v202, v25, s51, v202
    v_dot2_f32_bf16 v203, v25, s52, v203
    v_dot2_f32_bf16 v204, v26, s51, v204
    v_dot2_f32_bf16 v205, v26, s52, v205
    v_dot2_f32_bf16 v206, v27, s51, v206
    v_dot2_f32_bf16 v207, v27, s52, v207
    v_dot2_f32_bf16 v208, v28, s51, v208
    v_dot2_f32_bf16 v209, v28, s52, v209
    v_dot2_f32_bf16 v210, v29, s51, v210
    v_dot2_f32_bf16 v211, v29, s52, v211
    v_dot2_f32_bf16 v212, v30, s51, v212
    v_dot2_f32_bf16 v213, v30, s52, v213
    v_dot2_f32_bf16 v214, v31, s51, v214
    v_dot2_f32_bf16 v215, v31, s52, v215
    v_dot2_f32_bf16 v216, v32, s51, v216
    v_dot2_f32_bf16 v217, v32, s52, v217
    v_dot2_f32_bf16 v218, v33, s51, v218
    v_dot2_f32_bf16 v219, v33, s52, v219
    v_dot2_f32_bf16 v220, v34, s51, v220
    v_dot2_f32_bf16 v221, v34, s52, v221
    v_dot2_f32_bf16 v222, v35, s51, v222
    v_dot2_f32_bf16 v223, v35, s52, v223
    v_cvt_pk_bf16_f32 v160, v160, v161
    v_cvt_pk_bf16_f32 v161, v162, v163
    v_cvt_pk_bf16_f32 v162, v164, v165
    v_cvt_pk_bf16_f32 v163, v166, v167
    v_cvt_pk_bf16_f32 v164, v168, v169
    v_cvt_pk_bf16_f32 v165, v170, v171
    v_mfma_f32_32x32x16_bf16 v[176:191], v[232:235], v[160:163], v[176:191]
    v_cvt_pk_bf16_f32 v166, v172, v173
    v_cvt_pk_bf16_f32 v167, v174, v175
    v_lshrrev_b32_e64 v11, 9, v1
    v_mad_u32_u24 v0, v1, 13, s49
    v_mfma_f32_32x32x16_bf16 v[176:191], v[244:247], v[164:167], v[176:191]
    v_mad_i32_i24 v0, v11, s13, v0
    v_bfe_u32 v11, v6, 16, 12
    v_lshrrev_b32 v9, 28, v6
    v_lshl_add_u32 v9, v9, 4, v11
    v_add_u32_e64 v9, s49, v9
    v_mfma_f32_32x32x16_bf16 v[192:207], v[236:239], v[160:163], v[192:207]
    v_mfma_f32_32x32x16_bf16 v[192:207], v[248:251], v[164:167], v[192:207]
    v_cvt_pk_bf16_f32 v64, v176, v177
    v_cvt_pk_bf16_f32 v65, v178, v179
    v_cvt_pk_bf16_f32 v66, v180, v181
    v_cvt_pk_bf16_f32 v67, v182, v183
    v_mfma_f32_32x32x16_bf16 v[208:223], v[240:243], v[160:163], v[208:223]
    ds_write_b128 v0, v[64:67]
    v_cvt_pk_bf16_f32 v68, v184, v185
    v_cvt_pk_bf16_f32 v69, v186, v187
    v_cvt_pk_bf16_f32 v70, v188, v189
    v_cvt_pk_bf16_f32 v71, v190, v191
    v_mfma_f32_32x32x16_bf16 v[208:223], v[252:255], v[164:167], v[208:223]
    ds_write_b128 v0, v[68:71] offset:32
    ds_read_b128 v[64:67], v9
    s_nop 0
    ds_read_b128 v[68:71], v9 offset:3328
    v_cvt_pk_bf16_f32 v72, v192, v193
    v_cvt_pk_bf16_f32 v73, v194, v195
    v_cvt_pk_bf16_f32 v74, v196, v197
    v_cvt_pk_bf16_f32 v75, v198, v199
    v_cvt_pk_bf16_f32 v76, v200, v201
    v_cvt_pk_bf16_f32 v77, v202, v203
    v_cvt_pk_bf16_f32 v78, v204, v205
    v_cvt_pk_bf16_f32 v79, v206, v207
    ds_write_b128 v0, v[72:75] offset:64
    ds_write_b128 v0, v[76:79] offset:96
    s_nop 0
    ds_read_b128 v[72:75], v9 offset:64
    ds_read_b128 v[76:79], v9 offset:3392
    s_waitcnt lgkmcnt(5)
    buffer_store_dwordx4 v[64:67], v11, s[24:27], 0 offen sc1 nt
    s_waitcnt lgkmcnt(4)
    buffer_store_dwordx4 v[68:71], v11, s[8:11], 0 offen sc1 nt
    v_cvt_pk_bf16_f32 v80, v208, v209
    v_cvt_pk_bf16_f32 v81, v210, v211
    v_cvt_pk_bf16_f32 v82, v212, v213
    v_cvt_pk_bf16_f32 v83, v214, v215
    v_cvt_pk_bf16_f32 v84, v216, v217
    v_cvt_pk_bf16_f32 v85, v218, v219
    v_cvt_pk_bf16_f32 v86, v220, v221
    v_cvt_pk_bf16_f32 v87, v222, v223
    ds_write_b128 v0, v[80:83] offset:128
    ds_write_b128 v0, v[84:87] offset:160
    s_nop 0
    ds_read_b128 v[80:83], v9 offset:128
    ds_read_b128 v[84:87], v9 offset:3456
    s_waitcnt lgkmcnt(5)
    buffer_store_dwordx4 v[72:75], v11, s[24:27], 0 offen offset:64 sc1 nt
    s_waitcnt lgkmcnt(4)
    buffer_store_dwordx4 v[76:79], v11, s[8:11], 0 offen offset:64 sc1 nt
    s_waitcnt lgkmcnt(1)
    buffer_store_dwordx4 v[80:83], v11, s[24:27], 0 offen offset:128 sc1 nt
    s_waitcnt lgkmcnt(0)
    buffer_store_dwordx4 v[84:87], v11, s[8:11], 0 offen offset:128 sc1 nt
L_end:
    s_endpgm
.section .rodata,"a"
.p2align 6
.amdhsa_kernel standalone__convnext_block__vision_kernel
  .amdhsa_next_free_vgpr 512
  .amdhsa_next_free_sgpr 102
  .amdhsa_accum_offset 256
  .amdhsa_group_segment_fixed_size 0
  .amdhsa_kernarg_size 56
  .amdhsa_user_sgpr_count 2
  .amdhsa_user_sgpr_kernarg_segment_ptr 1
  .amdhsa_system_sgpr_workgroup_id_x 1
.end_amdhsa_kernel
```
